```python
import torch

def _softmax(x, axis=-1):
    return torch.softmax(x, dim=axis)
def _gelu(x):
    return torch.nn.functional.gelu(x, approximate="tanh")
def _silu(x):
    return torch.nn.functional.silu(x)
def _sigmoid(x):
    return torch.sigmoid(x)
def _layernorm(x, axis=-1, eps=1e-5):
    m = x.mean(dim=axis, keepdim=True)
    v = x.var(dim=axis, keepdim=True, unbiased=False)
    return (x - m) / torch.sqrt(v + eps)
def _scatter_add(tgt, idx, src, axis=0):
    return tgt.clone().index_add_(axis, idx, src)
def _segment_sum(src, seg, n):
    out = torch.zeros((n,) + src.shape[1:], dtype=src.dtype)
    return out.index_add_(0, seg, src)
def _pad(x, pw):
    flat = tuple(v for pair in reversed(pw) for v in pair)
    return torch.nn.functional.pad(x, flat)

kernel_name = 'sequential_preLN__sliding_local_dilated__swiglu_ffn__prompt'

def setup_inputs():

    _w = (lambda a: (lambda t: t.to(torch.bfloat16) if t.is_floating_point() else t)(torch.as_tensor(a)))
    def _A_setup():
        B, S, D = 1, 2048, 512
        return {
            "x": _w((lambda *s: torch.randn(*s, dtype=torch.bfloat16) * 0.05)(B, S, D)),
            "wqkv": _w((lambda *s: torch.randn(*s, dtype=torch.bfloat16) * 0.05)(D, 3 * D)),
            "wo": _w((lambda *s: torch.randn(*s, dtype=torch.bfloat16) * 0.05)(D, D)),
        }
    _A_in = _A_setup()

    def _B_setup():
        B, S, D, F = 1, 2048, 512, 1792
        return {
            "x": _w((lambda *s: torch.randn(*s, dtype=torch.bfloat16) * 0.05)(B, S, D)),
            "w_gate": _w((lambda *s: torch.randn(*s, dtype=torch.bfloat16) * 0.05)(D, F)),
            "w_up": _w((lambda *s: torch.randn(*s, dtype=torch.bfloat16) * 0.05)(D, F)),
            "w_down": _w((lambda *s: torch.randn(*s, dtype=torch.bfloat16) * 0.05)(F, D)),
        }
    _B_in = _B_setup()

    return {
        "A_x": _A_in["x"],
        "A_wqkv": _A_in["wqkv"],
        "A_wo": _A_in["wo"],
        "B_x": _B_in["x"],
        "B_w_gate": _B_in["w_gate"],
        "B_w_up": _B_in["w_up"],
        "B_w_down": _B_in["w_down"],
    }

def reference(A_x, A_wqkv, A_wo, B_x, B_w_gate, B_w_up, B_w_down):
    def _A_ref(x, wqkv, wo):
        B, S, D = x.shape
        H = 32; Dh = D // H
        W, dil = 8, 2
        qkv = (lambda x, *d: x.permute(*d))((x @ wqkv).reshape(B, S, 3, H, Dh), 2, 0, 3, 1, 4)
        q, k, v = qkv[0], qkv[1], qkv[2]
        scale = Dh ** -0.5
        pos = torch.arange(S)
        off = torch.arange(W) * dil
        idx = pos[:, None] - off[None, :]
        mask = idx >= 0
        idx_c = torch.where(mask, idx, 0).reshape(-1)
        kg = k[:, :, idx_c, :].reshape(B, H, S, W, Dh)
        vg = v[:, :, idx_c, :].reshape(B, H, S, W, Dh)
        logits = torch.einsum("bhsd,bhswd->bhsw", q, kg) * scale
        logits = torch.where(mask[None, None, :, :], logits, -1e9)
        attn = _softmax(logits, axis=-1)
        o = torch.einsum("bhsw,bhswd->bhsd", attn, vg)
        return (lambda x, *d: x.permute(*d))(o, 0, 2, 1, 3).reshape(B, S, D) @ wo

    def _B_ref(x, w_gate, w_up, w_down):
        g = _silu(x @ w_gate)
        u = x @ w_up
        return (g * u) @ w_down

    x = A_x
    h = x + _A_ref(_layernorm(x, axis=-1), A_wqkv, A_wo)
    h2 = h + _B_ref(_layernorm(h, axis=-1), B_w_gate, B_w_up, B_w_down)
    return h2
```

```asm
; @launch kernel=mega_kernel grid=(256,1,1) block=(512,1,1) lds=163840
.amdgcn_target "amdgcn-amd-amdhsa--gfx950"
.text
.globl mega_kernel
.p2align 8
.type mega_kernel,@function
mega_kernel:
  s_cmp_ge_u32 s2, 256
  s_cbranch_scc1 mega_kernel_end
  s_load_dwordx16 s[16:31], s[0:1], 0
  s_load_dwordx4 s[32:35], s[0:1], 64
  v_lshrrev_b32 v1, 6, v0
  v_and_b32 v0, 63, v0
  s_and_b32 s60, s2, 7
  v_readfirstlane_b32 s52, v1
  s_lshr_b32 s59, s2, 3
  s_xor_b32 s59, s59, 0
  s_lshl_b32 s55, s60, 2
  s_lshr_b32 s61, s59, 3
  s_add_u32 s55, s55, s61
  s_and_b32 s56, s59, 7
  s_xor_b32 s56, s56, 5
  s_lshr_b32 s57, s55, 1
  s_and_b32 s58, s59, 15
  s_mov_b32 s53, s55
  s_mov_b32 s54, s56
  s_cmp_ge_u32 s52, 4
  s_cbranch_scc1 loader
  v_lshlrev_b32 v6, 7, v0
  s_cmp_lg_u32 s52, 2
  s_cbranch_scc1 nz_1
  s_cmp_lg_u32 s2, 0
  s_cbranch_scc1 nz_1
  s_waitcnt lgkmcnt(0)
  s_memrealtime s[22:23]
  s_mov_b64 exec, 1
  v_mov_b32 v3, 0
  s_waitcnt lgkmcnt(0)
  s_or_b32 s22, s22, 1
  v_mov_b32 v12, s22
  v_mov_b32 v13, s23
  global_store_dwordx2 v3, v[12:13], s[32:33] sc1
  s_mov_b64 exec, -1
nz_1:
  s_cmp_lg_u32 s52, 1
  s_cbranch_scc1 pro_2
  s_lshl_b32 s61, s53, 3
  s_add_u32 s61, s61, s54
  s_lshl_b32 s61, s61, 3
  v_and_b32 v3, 7, v0
  v_add_u32 v3, s61, v3
  v_lshrrev_b32 v4, 3, v0
  s_mul_i32 s61, s53, 2
  s_add_u32 s61, s61, 3
  v_add_u32 v4, s61, v4
  v_and_b32 v4, 7, v4
  v_lshlrev_b32 v4, 7, v4
  v_lshl_add_u32 v3, v3, 10, v4
  s_mov_b32 exec_hi, 0xff
  s_waitcnt lgkmcnt(0)
  s_sleep 0
  global_load_dword v7, v3, s[16:17]
  s_mov_b64 exec, -1
pro_2:
  s_waitcnt lgkmcnt(0)
  s_mov_b32 s44, s34
  s_mov_b32 s45, s35
  s_mov_b32 s46, 18874368
  s_mov_b32 s47, 0x20000
  s_mov_b32 s36, s24
  s_mov_b32 s37, s25
  s_mov_b32 s38, 1835008
  s_mov_b32 s39, 0x20000
  s_mov_b32 s40, s26
  s_mov_b32 s41, s27
  s_mov_b32 s42, 1835008
  s_mov_b32 s43, 0x20000
  s_lshl_b32 s65, s53, 6
  v_and_b32 v1, 15, v0
  v_lshrrev_b32 v2, 4, v0
  v_lshrrev_b32 v3, 1, v1
  v_xor_b32 v3, v2, v3
  v_lshlrev_b32 v3, 4, v3
  v_lshl_add_u32 v160, v1, 7, v3
  v_xor_b32 v161, 64, v160
  s_add_u32 s61, s52, 1
  s_lshl_b32 s61, s61, 11
  v_add_u32 v162, s61, v160
  v_add_u32 v163, s61, v161
  v_lshrrev_b32 v3, 3, v1
  v_and_b32 v4, 1, v2
  v_lshl_or_b32 v3, v4, 1, v3
  v_lshlrev_b32 v3, 1, v3
  v_bfe_u32 v4, v1, 1, 1
  s_lshl_b32 s61, s52, 1
  v_add_u32 v4, s61, v4
  v_xor_b32 v3, v3, v4
  v_lshlrev_b32 v3, 4, v3
  v_and_b32 v4, 1, v1
  v_lshl_add_u32 v3, v4, 3, v3
  v_lshrrev_b32 v4, 2, v1
  v_lshl_add_u32 v3, v4, 7, v3
  v_mul_u32_u24 v4, 3072, v2
  v_add3_u32 v164, v3, v4, 0
  v_add_u32 v164, 10240, v164
  v_mov_b32 v165, v160
  v_mov_b32 v166, v161
  v_mov_b32 v167, v162
  v_mov_b32 v168, v163
  v_mov_b32 v169, v164
  v_mov_b32 v12, 0
  v_mov_b32 v13, 0
  v_mov_b32 v14, 0
  v_mov_b32 v15, 0
  v_mov_b32 v16, 0
  v_mov_b32 v17, 0
  v_mov_b32 v18, 0
  v_mov_b32 v19, 0
  v_mov_b32 v20, 0
  v_mov_b32 v21, 0
  v_mov_b32 v22, 0
  v_mov_b32 v23, 0
  v_mov_b32 v24, 0
  v_mov_b32 v25, 0
  v_mov_b32 v26, 0
  v_mov_b32 v27, 0
  v_mov_b32 v28, 0
  v_mov_b32 v29, 0
  v_mov_b32 v30, 0
  v_mov_b32 v31, 0
  v_mov_b32 v32, 0
  v_mov_b32 v33, 0
  v_mov_b32 v34, 0
  v_mov_b32 v35, 0
  v_mov_b32 v36, 0
  v_mov_b32 v37, 0
  v_mov_b32 v38, 0
  v_mov_b32 v39, 0
  v_mov_b32 v40, 0
  v_mov_b32 v41, 0
  v_mov_b32 v42, 0
  v_mov_b32 v43, 0
  v_mov_b32 v44, 0
  v_mov_b32 v45, 0
  v_mov_b32 v46, 0
  v_mov_b32 v47, 0
  v_mov_b32 v48, 0
  v_mov_b32 v49, 0
  v_mov_b32 v50, 0
  v_mov_b32 v51, 0
  v_mov_b32 v52, 0
  v_mov_b32 v53, 0
  v_mov_b32 v54, 0
  v_mov_b32 v55, 0
  v_mov_b32 v56, 0
  v_mov_b32 v57, 0
  v_mov_b32 v58, 0
  v_mov_b32 v59, 0
  v_mov_b32 v60, 0
  v_mov_b32 v61, 0
  v_mov_b32 v62, 0
  v_mov_b32 v63, 0
  v_mov_b32 v64, 0
  v_mov_b32 v65, 0
  v_mov_b32 v66, 0
  v_mov_b32 v67, 0
  v_mov_b32 v68, 0
  v_mov_b32 v69, 0
  v_mov_b32 v70, 0
  v_mov_b32 v71, 0
  v_mov_b32 v72, 0
  v_mov_b32 v73, 0
  v_mov_b32 v74, 0
  v_mov_b32 v75, 0
  v_mov_b32 v76, 0
  v_mov_b32 v77, 0
  v_mov_b32 v78, 0
  v_mov_b32 v79, 0
  v_mov_b32 v80, 0
  v_mov_b32 v81, 0
  v_mov_b32 v82, 0
  v_mov_b32 v83, 0
  v_mov_b32 v84, 0x3f803f80
  v_mov_b32 v88, 0x3f803f80
  v_mov_b32 v112, 0x3f803f80
  v_mov_b32 v85, 0x3f803f80
  v_mov_b32 v89, 0x3f803f80
  v_mov_b32 v113, 0x3f803f80
  v_mov_b32 v86, 0x3f803f80
  v_mov_b32 v90, 0x3f803f80
  v_mov_b32 v114, 0x3f803f80
  v_mov_b32 v87, 0x3f803f80
  v_mov_b32 v91, 0x3f803f80
  v_mov_b32 v115, 0x3f803f80
  s_mov_b32 s68, 0xfffefffe
  s_mov_b32 s69, 0xfffefffe
  s_mov_b32 s66, 0
  s_mov_b32 s67, 0
  s_lshl_b32 s61, s59, 14
  s_add_u32 s70, s20, s61
  s_addc_u32 s71, s21, 0
  s_mov_b32 s72, 99
  s_cmp_eq_u32 s52, 0
  s_cselect_b32 s72, 3, s72
  s_cmp_eq_u32 s52, 3
  s_cselect_b32 s72, 2, s72
  s_barrier
  ds_read_b64_tr_b16 v[136:137], v169 offset:0
  ds_read_b64_tr_b16 v[138:139], v169 offset:512
  s_mov_b64 exec, s[68:69]
  ds_read_b128 v[88:91], v165
  s_mov_b64 exec, -1
  ds_read_b64_tr_b16 v[140:141], v169 offset:1024
  ds_read_b64_tr_b16 v[142:143], v169 offset:1536
  ds_read_b64_tr_b16 v[144:145], v169 offset:2048
  ds_read_b64_tr_b16 v[146:147], v169 offset:2560
  ds_read_b128 v[92:95], v165 offset:2048
  ds_read_b128 v[96:99], v165 offset:4096
  ds_read_b128 v[100:103], v165 offset:6144
  ds_read_b128 v[104:107], v165 offset:8192
  ds_read_b128 v[108:111], v167
s1_loop:
  s_cmp_eq_u32 s67, s72
  s_cbranch_scc1 s1_job
s1_nojob:
  s_waitcnt lgkmcnt(0)
  v_mfma_f32_16x16x32_bf16 v[12:15], v[136:139], v[88:91], v[12:15]
  ds_read_b64_tr_b16 v[148:149], v169 offset:12288
  v_mfma_f32_16x16x32_bf16 v[32:35], v[140:143], v[88:91], v[32:35]
  ds_read_b64_tr_b16 v[150:151], v169 offset:12800
  v_mfma_f32_16x16x32_bf16 v[52:55], v[88:91], v[144:147], v[52:55]
  s_mov_b64 exec, s[68:69]
  ds_read_b128 v[112:115], v166
  s_mov_b64 exec, -1
  v_mfma_f32_16x16x32_bf16 v[16:19], v[136:139], v[92:95], v[16:19]
  ds_read_b64_tr_b16 v[152:153], v169 offset:13312
  v_mfma_f32_16x16x32_bf16 v[36:39], v[140:143], v[92:95], v[36:39]
  ds_read_b64_tr_b16 v[154:155], v169 offset:13824
  v_mfma_f32_16x16x32_bf16 v[56:59], v[92:95], v[144:147], v[56:59]
  ds_read_b64_tr_b16 v[156:157], v169 offset:14336
  v_mfma_f32_16x16x32_bf16 v[20:23], v[136:139], v[96:99], v[20:23]
  ds_read_b64_tr_b16 v[158:159], v169 offset:14848
  v_mfma_f32_16x16x32_bf16 v[40:43], v[140:143], v[96:99], v[40:43]
  ds_read_b128 v[116:119], v166 offset:2048
  v_mfma_f32_16x16x32_bf16 v[60:63], v[96:99], v[144:147], v[60:63]
  ds_read_b128 v[120:123], v166 offset:4096
  v_mfma_f32_16x16x32_bf16 v[24:27], v[136:139], v[100:103], v[24:27]
  ds_read_b128 v[124:127], v166 offset:6144
  v_mfma_f32_16x16x32_bf16 v[44:47], v[140:143], v[100:103], v[44:47]
  ds_read_b128 v[128:131], v166 offset:8192
  v_mfma_f32_16x16x32_bf16 v[64:67], v[100:103], v[144:147], v[64:67]
  ds_read_b128 v[132:135], v168
  v_mfma_f32_16x16x32_bf16 v[28:31], v[136:139], v[104:107], v[28:31]
  v_mfma_f32_16x16x32_bf16 v[48:51], v[140:143], v[104:107], v[48:51]
  v_mfma_f32_16x16x32_bf16 v[68:71], v[104:107], v[144:147], v[68:71]
  v_mfma_f32_16x16x32_bf16 v[80:83], v[88:91], v[88:91], v[80:83]
  v_mfma_f32_16x16x32_bf16 v[72:75], v[108:111], v[108:111], v[72:75]
  v_mfma_f32_16x16x32_bf16 v[76:79], v[84:87], v[108:111], v[76:79]
  s_waitcnt lgkmcnt(0)
  v_mfma_f32_16x16x32_bf16 v[12:15], v[148:151], v[112:115], v[12:15]
  v_mfma_f32_16x16x32_bf16 v[32:35], v[152:155], v[112:115], v[32:35]
  s_cmp_eq_u32 s67, 7
  s_cbranch_scc1 s1_last
  s_add_u32 s66, s66, 34816
  s_cmp_eq_u32 s66, 139264
  s_cselect_b32 s66, 0, s66
  s_add_u32 s67, s67, 1
  v_add_u32 v169, s66, v164
  v_add_u32 v165, s66, v160
  v_add_u32 v167, s66, v162
  s_barrier
  v_mfma_f32_16x16x32_bf16 v[52:55], v[112:115], v[156:159], v[52:55]
  ds_read_b64_tr_b16 v[136:137], v169 offset:0
  v_mfma_f32_16x16x32_bf16 v[16:19], v[148:151], v[116:119], v[16:19]
  ds_read_b64_tr_b16 v[138:139], v169 offset:512
  v_mfma_f32_16x16x32_bf16 v[36:39], v[152:155], v[116:119], v[36:39]
  s_mov_b64 exec, s[68:69]
  ds_read_b128 v[88:91], v165
  s_mov_b64 exec, -1
  v_mfma_f32_16x16x32_bf16 v[56:59], v[116:119], v[156:159], v[56:59]
  ds_read_b64_tr_b16 v[140:141], v169 offset:1024
  v_mfma_f32_16x16x32_bf16 v[20:23], v[148:151], v[120:123], v[20:23]
  ds_read_b64_tr_b16 v[142:143], v169 offset:1536
  v_mfma_f32_16x16x32_bf16 v[40:43], v[152:155], v[120:123], v[40:43]
  ds_read_b64_tr_b16 v[144:145], v169 offset:2048
  v_mfma_f32_16x16x32_bf16 v[60:63], v[120:123], v[156:159], v[60:63]
  ds_read_b64_tr_b16 v[146:147], v169 offset:2560
  v_mfma_f32_16x16x32_bf16 v[24:27], v[148:151], v[124:127], v[24:27]
  ds_read_b128 v[92:95], v165 offset:2048
  v_mfma_f32_16x16x32_bf16 v[44:47], v[152:155], v[124:127], v[44:47]
  ds_read_b128 v[96:99], v165 offset:4096
  v_mfma_f32_16x16x32_bf16 v[64:67], v[124:127], v[156:159], v[64:67]
  ds_read_b128 v[100:103], v165 offset:6144
  v_mfma_f32_16x16x32_bf16 v[28:31], v[148:151], v[128:131], v[28:31]
  ds_read_b128 v[104:107], v165 offset:8192
  v_mfma_f32_16x16x32_bf16 v[48:51], v[152:155], v[128:131], v[48:51]
  ds_read_b128 v[108:111], v167
  v_mfma_f32_16x16x32_bf16 v[68:71], v[128:131], v[156:159], v[68:71]
  v_add_u32 v166, s66, v161
  v_mfma_f32_16x16x32_bf16 v[80:83], v[112:115], v[112:115], v[80:83]
  v_add_u32 v168, s66, v163
  v_mfma_f32_16x16x32_bf16 v[72:75], v[132:135], v[132:135], v[72:75]
  v_mfma_f32_16x16x32_bf16 v[76:79], v[84:87], v[132:135], v[76:79]
  s_branch s1_loop
s1_job:
  s_cmp_eq_u32 s52, 0
  s_cbranch_scc1 s1_job0
  v_add_u32 v4, 8192, v6
  global_load_dword v7, v6, s[70:71]
  global_load_dword v7, v4, s[70:71]
  s_branch s1_nojob
s1_job0:
  v_mov_b32 v3, 0
  global_load_dwordx2 v[8:9], v3, s[32:33]
  s_branch s1_nojob
s1_last:
  v_mfma_f32_16x16x32_bf16 v[80:83], v[112:115], v[112:115], v[80:83]
  v_and_b32 v3, 1, v1
  v_lshl_add_u32 v4, v2, 2, v3
  v_mfma_f32_16x16x32_bf16 v[72:75], v[132:135], v[132:135], v[72:75]
  v_cmp_le_u32 s[72:73], v4, v1
  v_add_u32 v4, 2, v4
  v_mfma_f32_16x16x32_bf16 v[76:79], v[84:87], v[132:135], v[76:79]
  v_cmp_le_u32 s[74:75], v4, v1
  v_mov_b32 v5, 0xffff
  v_mfma_f32_16x16x32_bf16 v[52:55], v[112:115], v[156:159], v[52:55]
  v_lshlrev_b32 v3, 4, v3
  v_lshlrev_b32 v5, v3, v5
  v_mfma_f32_16x16x32_bf16 v[16:19], v[148:151], v[116:119], v[16:19]
  v_cndmask_b32 v89, v5, 0, s[72:73]
  v_cndmask_b32 v90, v5, 0, s[74:75]
  v_mfma_f32_16x16x32_bf16 v[36:39], v[152:155], v[116:119], v[36:39]
  v_cndmask_b32 v91, 0, v5, s[72:73]
  v_cndmask_b32 v92, 0, v5, s[74:75]
  v_mfma_f32_16x16x32_bf16 v[56:59], v[116:119], v[156:159], v[56:59]
  s_not_b64 s[76:77], s[72:73]
  s_not_b64 s[78:79], s[74:75]
  v_mfma_f32_16x16x32_bf16 v[20:23], v[148:151], v[120:123], v[20:23]
  s_cmp_eq_u32 s65, 0
  s_cselect_b64 s[76:77], s[76:77], 0
  v_mfma_f32_16x16x32_bf16 v[40:43], v[152:155], v[120:123], v[40:43]
  s_cselect_b64 s[78:79], s[78:79], 0
  s_mov_b32 s66, 0xaaaaaaaa
  v_mfma_f32_16x16x32_bf16 v[60:63], v[120:123], v[156:159], v[60:63]
  s_mov_b32 s67, 0xaaaaaaaa
  s_mov_b32 s68, 0xcccccccc
  v_mfma_f32_16x16x32_bf16 v[24:27], v[148:151], v[124:127], v[24:27]
  s_mov_b32 s69, 0xcccccccc
  s_mov_b32 s70, 0x00f0000f
  v_mfma_f32_16x16x32_bf16 v[44:47], v[152:155], v[124:127], v[44:47]
  s_mov_b32 s71, 0xf0000f00
  s_mov_b32 s98, 0x3b000000
  v_mfma_f32_16x16x32_bf16 v[64:67], v[124:127], v[156:159], v[64:67]
  s_mov_b32 s99, 0x3727c5ac
  s_mov_b32 s100, 0x3eb8aa3b
  v_mfma_f32_16x16x32_bf16 v[28:31], v[148:151], v[128:131], v[28:31]
  s_mov_b32 s101, 0xf149f2ca
  v_lshlrev_b32 v88, 2, v1
  v_mfma_f32_16x16x32_bf16 v[48:51], v[152:155], v[128:131], v[48:51]
  v_add_u32 v88, 69632, v88
  v_mfma_f32_16x16x32_bf16 v[68:71], v[128:131], v[156:159], v[68:71]
  v_cndmask_b32 v93, v72, v73, s[66:67]
  v_cndmask_b32 v94, v74, v75, s[66:67]
  v_cndmask_b32 v93, v93, v94, s[68:69]
  v_mul_f32 v95, s98, v76
  v_mul_f32 v94, s98, v93
  v_fma_f32 v94, -v95, v95, v94
  v_max_f32 v94, 0, v94
  v_cvt_pk_bf16_f32 v95, v95, v95
  v_lshlrev_b32 v95, 16, v95
  v_cvt_pk_bf16_f32 v94, v94, v94
  v_lshlrev_b32 v94, 16, v94
  v_add_f32 v94, s99, v94
  v_cvt_pk_bf16_f32 v94, v94, v94
  v_lshlrev_b32 v94, 16, v94
  v_sqrt_f32 v94, v94
  s_nop 0
  v_cvt_pk_bf16_f32 v94, v94, v94
  v_lshlrev_b32 v94, 16, v94
  v_rcp_f32 v96, v94
  s_nop 0
  v_mov_b32_dpp v76, v80 row_newbcast:0 row_mask:0xf bank_mask:0xf
  v_mov_b32_dpp v77, v81 row_newbcast:0 row_mask:0xf bank_mask:0xf
  v_mov_b32_dpp v78, v82 row_newbcast:0 row_mask:0xf bank_mask:0xf
  v_mov_b32_dpp v79, v83 row_newbcast:0 row_mask:0xf bank_mask:0xf
  v_cndmask_b32 v93, v80, v81, s[66:67]
  v_cndmask_b32 v94, v82, v83, s[66:67]
  v_cndmask_b32 v93, v93, v94, s[68:69]
  v_cndmask_b32 v99, v76, v77, s[66:67]
  v_cndmask_b32 v100, v78, v79, s[66:67]
  v_cndmask_b32 v99, v99, v100, s[68:69]
  v_mul_f32 v97, s98, v99
  v_mul_f32 v94, s98, v93
  v_fma_f32 v94, -v97, v97, v94
  v_max_f32 v94, 0, v94
  v_cvt_pk_bf16_f32 v97, v97, v97
  v_lshlrev_b32 v97, 16, v97
  v_cvt_pk_bf16_f32 v94, v94, v94
  v_lshlrev_b32 v94, 16, v94
  v_add_f32 v94, s99, v94
  v_cvt_pk_bf16_f32 v94, v94, v94
  v_lshlrev_b32 v94, 16, v94
  v_sqrt_f32 v94, v94
  s_nop 0
  v_cvt_pk_bf16_f32 v94, v94, v94
  v_lshlrev_b32 v94, 16, v94
  v_rcp_f32 v98, v94
  s_nop 0
  s_add_u32 s61, s52, 1
  s_lshl_b32 s61, s61, 6
  v_add_u32 v93, s61, v88
  s_mov_b64 exec, s[70:71]
  ds_write2_b32 v93, v95, v96 offset0:0 offset1:80
  ds_write2_b32 v88, v97, v98 offset0:0 offset1:80
  s_mov_b64 exec, -1
  v_mov_b32_dpp v104, v12 row_newbcast:0 row_mask:0xf bank_mask:0xf
  v_mov_b32_dpp v108, v32 row_newbcast:0 row_mask:0xf bank_mask:0xf
  v_mov_b32_dpp v105, v13 row_newbcast:0 row_mask:0xf bank_mask:0xf
  v_mov_b32_dpp v109, v33 row_newbcast:0 row_mask:0xf bank_mask:0xf
  v_mov_b32_dpp v106, v14 row_newbcast:0 row_mask:0xf bank_mask:0xf
  v_mov_b32_dpp v110, v34 row_newbcast:0 row_mask:0xf bank_mask:0xf
  v_mov_b32_dpp v107, v15 row_newbcast:0 row_mask:0xf bank_mask:0xf
  v_mov_b32_dpp v111, v35 row_newbcast:0 row_mask:0xf bank_mask:0xf
  v_lshlrev_b32 v93, 2, v1
  ds_bpermute_b32 v112, v93, v52
  s_waitcnt lgkmcnt(0)
  s_barrier
  v_lshlrev_b32 v93, 4, v2
  v_add_u32 v93, 69632, v93
  ds_read2_b32 v[114:115], v88 offset0:0 offset1:80
  ds_read2_b32 v[116:117], v88 offset0:16 offset1:96
  ds_read2_b32 v[118:119], v88 offset0:32 offset1:112
  ds_read2_b32 v[120:121], v88 offset0:48 offset1:128
  ds_read2_b32 v[122:123], v88 offset0:64 offset1:144
  ds_read_b128 v[124:127], v93 offset:0
  ds_read_b128 v[144:147], v93 offset:320
  ds_read_b128 v[128:131], v93 offset:64
  ds_read_b128 v[148:151], v93 offset:384
  ds_read_b128 v[132:135], v93 offset:128
  ds_read_b128 v[152:155], v93 offset:448
  ds_read_b128 v[136:139], v93 offset:192
  ds_read_b128 v[156:159], v93 offset:512
  ds_read_b128 v[140:143], v93 offset:256
  ds_read_b128 v[160:163], v93 offset:576
  s_waitcnt lgkmcnt(10)
  v_pk_fma_f32 v[32:33], v[114:115], v[108:109], v[32:33] op_sel_hi:[0,1,1] neg_lo:[1,0,0] neg_hi:[1,0,0]
  v_pk_fma_f32 v[34:35], v[114:115], v[110:111], v[34:35] op_sel_hi:[0,1,1] neg_lo:[1,0,0] neg_hi:[1,0,0]
  v_pk_mul_f32 v[32:33], v[32:33], v[114:115] op_sel:[0,1] op_sel_hi:[1,1]
  v_pk_mul_f32 v[34:35], v[34:35], v[114:115] op_sel:[0,1] op_sel_hi:[1,1]
  v_cvt_pk_bf16_f32 v172, v32, v33
  v_cvt_pk_bf16_f32 v173, v34, v35
  v_pk_fma_f32 v[36:37], v[116:117], v[108:109], v[36:37] op_sel_hi:[0,1,1] neg_lo:[1,0,0] neg_hi:[1,0,0]
  v_pk_fma_f32 v[38:39], v[116:117], v[110:111], v[38:39] op_sel_hi:[0,1,1] neg_lo:[1,0,0] neg_hi:[1,0,0]
  v_pk_mul_f32 v[36:37], v[36:37], v[116:117] op_sel:[0,1] op_sel_hi:[1,1]
  v_pk_mul_f32 v[38:39], v[38:39], v[116:117] op_sel:[0,1] op_sel_hi:[1,1]
  v_cvt_pk_bf16_f32 v174, v36, v37
  v_cvt_pk_bf16_f32 v175, v38, v39
  v_pk_fma_f32 v[16:17], v[116:117], v[104:105], v[16:17] op_sel_hi:[0,1,1] neg_lo:[1,0,0] neg_hi:[1,0,0]
  v_pk_fma_f32 v[18:19], v[116:117], v[106:107], v[18:19] op_sel_hi:[0,1,1] neg_lo:[1,0,0] neg_hi:[1,0,0]
  v_pk_mul_f32 v[16:17], v[16:17], v[116:117] op_sel:[0,1] op_sel_hi:[1,1]
  v_pk_mul_f32 v[18:19], v[18:19], v[116:117] op_sel:[0,1] op_sel_hi:[1,1]
  v_cvt_pk_bf16_f32 v164, v16, v17
  v_cvt_pk_bf16_f32 v165, v18, v19
  v_pk_fma_f32 v[40:41], v[118:119], v[108:109], v[40:41] op_sel_hi:[0,1,1] neg_lo:[1,0,0] neg_hi:[1,0,0]
  v_pk_fma_f32 v[42:43], v[118:119], v[110:111], v[42:43] op_sel_hi:[0,1,1] neg_lo:[1,0,0] neg_hi:[1,0,0]
  v_pk_mul_f32 v[40:41], v[40:41], v[118:119] op_sel:[0,1] op_sel_hi:[1,1]
  v_pk_mul_f32 v[42:43], v[42:43], v[118:119] op_sel:[0,1] op_sel_hi:[1,1]
  v_cvt_pk_bf16_f32 v176, v40, v41
  v_cvt_pk_bf16_f32 v177, v42, v43
  v_pk_fma_f32 v[20:21], v[118:119], v[104:105], v[20:21] op_sel_hi:[0,1,1] neg_lo:[1,0,0] neg_hi:[1,0,0]
  v_pk_fma_f32 v[22:23], v[118:119], v[106:107], v[22:23] op_sel_hi:[0,1,1] neg_lo:[1,0,0] neg_hi:[1,0,0]
  v_pk_mul_f32 v[20:21], v[20:21], v[118:119] op_sel:[0,1] op_sel_hi:[1,1]
  v_pk_mul_f32 v[22:23], v[22:23], v[118:119] op_sel:[0,1] op_sel_hi:[1,1]
  v_cvt_pk_bf16_f32 v166, v20, v21
  v_cvt_pk_bf16_f32 v167, v22, v23
  v_pk_fma_f32 v[44:45], v[120:121], v[108:109], v[44:45] op_sel_hi:[0,1,1] neg_lo:[1,0,0] neg_hi:[1,0,0]
  v_pk_fma_f32 v[46:47], v[120:121], v[110:111], v[46:47] op_sel_hi:[0,1,1] neg_lo:[1,0,0] neg_hi:[1,0,0]
  v_pk_mul_f32 v[44:45], v[44:45], v[120:121] op_sel:[0,1] op_sel_hi:[1,1]
  v_pk_mul_f32 v[46:47], v[46:47], v[120:121] op_sel:[0,1] op_sel_hi:[1,1]
  v_cvt_pk_bf16_f32 v178, v44, v45
  v_cvt_pk_bf16_f32 v179, v46, v47
  v_pk_fma_f32 v[24:25], v[120:121], v[104:105], v[24:25] op_sel_hi:[0,1,1] neg_lo:[1,0,0] neg_hi:[1,0,0]
  v_pk_fma_f32 v[26:27], v[120:121], v[106:107], v[26:27] op_sel_hi:[0,1,1] neg_lo:[1,0,0] neg_hi:[1,0,0]
  v_pk_mul_f32 v[24:25], v[24:25], v[120:121] op_sel:[0,1] op_sel_hi:[1,1]
  v_pk_mul_f32 v[26:27], v[26:27], v[120:121] op_sel:[0,1] op_sel_hi:[1,1]
  v_cvt_pk_bf16_f32 v168, v24, v25
  v_cvt_pk_bf16_f32 v169, v26, v27
  v_pk_fma_f32 v[48:49], v[122:123], v[108:109], v[48:49] op_sel_hi:[0,1,1] neg_lo:[1,0,0] neg_hi:[1,0,0]
  v_pk_fma_f32 v[50:51], v[122:123], v[110:111], v[50:51] op_sel_hi:[0,1,1] neg_lo:[1,0,0] neg_hi:[1,0,0]
  v_pk_mul_f32 v[48:49], v[48:49], v[122:123] op_sel:[0,1] op_sel_hi:[1,1]
  v_pk_mul_f32 v[50:51], v[50:51], v[122:123] op_sel:[0,1] op_sel_hi:[1,1]
  v_cvt_pk_bf16_f32 v180, v48, v49
  v_cvt_pk_bf16_f32 v181, v50, v51
  v_pk_fma_f32 v[28:29], v[122:123], v[104:105], v[28:29] op_sel_hi:[0,1,1] neg_lo:[1,0,0] neg_hi:[1,0,0]
  v_pk_fma_f32 v[30:31], v[122:123], v[106:107], v[30:31] op_sel_hi:[0,1,1] neg_lo:[1,0,0] neg_hi:[1,0,0]
  v_pk_mul_f32 v[28:29], v[28:29], v[122:123] op_sel:[0,1] op_sel_hi:[1,1]
  v_pk_mul_f32 v[30:31], v[30:31], v[122:123] op_sel:[0,1] op_sel_hi:[1,1]
  v_cvt_pk_bf16_f32 v170, v28, v29
  v_cvt_pk_bf16_f32 v171, v30, v31
  s_nop 1
  v_mfma_f32_16x16x16_bf16 v[196:199], v[172:173], v[164:165], 0
  v_mfma_f32_16x16x16_bf16 v[212:215], v[174:175], v[164:165], 0
  v_mfma_f32_16x16x16_bf16 v[200:203], v[174:175], v[166:167], 0
  v_mfma_f32_16x16x16_bf16 v[216:219], v[176:177], v[166:167], 0
  v_mfma_f32_16x16x16_bf16 v[204:207], v[176:177], v[168:169], 0
  v_mfma_f32_16x16x16_bf16 v[220:223], v[178:179], v[168:169], 0
  v_mfma_f32_16x16x16_bf16 v[208:211], v[178:179], v[170:171], 0
  v_mfma_f32_16x16x16_bf16 v[224:227], v[180:181], v[170:171], 0
  s_waitcnt lgkmcnt(0)
  v_pk_fma_f32 v[52:53], v[124:125], v[112:113], v[52:53] op_sel_hi:[1,0,1] neg_lo:[1,0,0] neg_hi:[1,0,0]
  v_pk_fma_f32 v[54:55], v[126:127], v[112:113], v[54:55] op_sel_hi:[1,0,1] neg_lo:[1,0,0] neg_hi:[1,0,0]
  v_pk_mul_f32 v[52:53], v[52:53], v[144:145]
  v_pk_mul_f32 v[54:55], v[54:55], v[146:147]
  v_cvt_pk_bf16_f32 v184, v52, v53
  v_cvt_pk_bf16_f32 v185, v54, v55
  v_pk_fma_f32 v[56:57], v[128:129], v[112:113], v[56:57] op_sel_hi:[1,0,1] neg_lo:[1,0,0] neg_hi:[1,0,0]
  v_pk_fma_f32 v[58:59], v[130:131], v[112:113], v[58:59] op_sel_hi:[1,0,1] neg_lo:[1,0,0] neg_hi:[1,0,0]
  v_pk_mul_f32 v[56:57], v[56:57], v[148:149]
  v_pk_mul_f32 v[58:59], v[58:59], v[150:151]
  v_cvt_pk_bf16_f32 v186, v56, v57
  v_cvt_pk_bf16_f32 v187, v58, v59
  v_pk_fma_f32 v[60:61], v[132:133], v[112:113], v[60:61] op_sel_hi:[1,0,1] neg_lo:[1,0,0] neg_hi:[1,0,0]
  v_pk_fma_f32 v[62:63], v[134:135], v[112:113], v[62:63] op_sel_hi:[1,0,1] neg_lo:[1,0,0] neg_hi:[1,0,0]
  v_pk_mul_f32 v[60:61], v[60:61], v[152:153]
  v_pk_mul_f32 v[62:63], v[62:63], v[154:155]
  v_cvt_pk_bf16_f32 v188, v60, v61
  v_cvt_pk_bf16_f32 v189, v62, v63
  v_pk_fma_f32 v[64:65], v[136:137], v[112:113], v[64:65] op_sel_hi:[1,0,1] neg_lo:[1,0,0] neg_hi:[1,0,0]
  v_pk_fma_f32 v[66:67], v[138:139], v[112:113], v[66:67] op_sel_hi:[1,0,1] neg_lo:[1,0,0] neg_hi:[1,0,0]
  v_pk_mul_f32 v[64:65], v[64:65], v[156:157]
  v_pk_mul_f32 v[66:67], v[66:67], v[158:159]
  v_cvt_pk_bf16_f32 v190, v64, v65
  v_cvt_pk_bf16_f32 v191, v66, v67
  v_pk_fma_f32 v[68:69], v[140:141], v[112:113], v[68:69] op_sel_hi:[1,0,1] neg_lo:[1,0,0] neg_hi:[1,0,0]
  v_pk_fma_f32 v[70:71], v[142:143], v[112:113], v[70:71] op_sel_hi:[1,0,1] neg_lo:[1,0,0] neg_hi:[1,0,0]
  v_pk_mul_f32 v[68:69], v[68:69], v[160:161]
  v_pk_mul_f32 v[70:71], v[70:71], v[162:163]
  v_cvt_pk_bf16_f32 v192, v68, v69
  v_cvt_pk_bf16_f32 v193, v70, v71
  v_cndmask_b32 v196, v196, v197, s[66:67]
  v_cndmask_b32 v212, v212, v213, s[66:67]
  v_cndmask_b32 v198, v198, v199, s[66:67]
  v_cndmask_b32 v214, v214, v215, s[66:67]
  v_cndmask_b32 v228, v196, v212, s[72:73]
  v_cndmask_b32 v232, v198, v214, s[74:75]
  v_cndmask_b32 v200, v200, v201, s[66:67]
  v_cndmask_b32 v216, v216, v217, s[66:67]
  v_cndmask_b32 v202, v202, v203, s[66:67]
  v_cndmask_b32 v218, v218, v219, s[66:67]
  v_cndmask_b32 v229, v200, v216, s[72:73]
  v_cndmask_b32 v233, v202, v218, s[74:75]
  v_cndmask_b32 v204, v204, v205, s[66:67]
  v_cndmask_b32 v220, v220, v221, s[66:67]
  v_cndmask_b32 v206, v206, v207, s[66:67]
  v_cndmask_b32 v222, v222, v223, s[66:67]
  v_cndmask_b32 v230, v204, v220, s[72:73]
  v_cndmask_b32 v234, v206, v222, s[74:75]
  v_cndmask_b32 v208, v208, v209, s[66:67]
  v_cndmask_b32 v224, v224, v225, s[66:67]
  v_cndmask_b32 v210, v210, v211, s[66:67]
  v_cndmask_b32 v226, v226, v227, s[66:67]
  v_cndmask_b32 v231, v208, v224, s[72:73]
  v_cndmask_b32 v235, v210, v226, s[74:75]
  v_mov_b32 v240, s101
  v_cndmask_b32 v228, v228, v240, s[76:77]
  v_cndmask_b32 v232, v232, v240, s[78:79]
  v_max_f32 v236, v228, v232
  v_max_f32 v237, v229, v233
  v_max_f32 v238, v230, v234
  v_max_f32 v239, v231, v235
  v_mov_b32 v240, v236
  v_mov_b32 v241, v237
  v_mov_b32 v242, v238
  v_mov_b32 v243, v239
  v_permlane32_swap_b32 v236, v240
  v_permlane32_swap_b32 v237, v241
  v_permlane32_swap_b32 v238, v242
  v_permlane32_swap_b32 v239, v243
  v_max_f32 v236, v236, v240
  v_max_f32 v237, v237, v241
  v_max_f32 v238, v238, v242
  v_max_f32 v239, v239, v243
  v_mov_b32 v240, v236
  v_mov_b32 v241, v237
  v_mov_b32 v242, v238
  v_mov_b32 v243, v239
  v_permlane16_swap_b32 v236, v240
  v_permlane16_swap_b32 v237, v241
  v_permlane16_swap_b32 v238, v242
  v_permlane16_swap_b32 v239, v243
  v_max_f32 v236, v236, v240
  v_max_f32 v237, v237, v241
  v_max_f32 v238, v238, v242
  v_max_f32 v239, v239, v243
  v_mul_f32 v236, s100, v236
  v_mul_f32 v237, s100, v237
  v_mul_f32 v238, s100, v238
  v_mul_f32 v239, s100, v239
  v_fma_f32 v228, v228, s100, -v236
  v_fma_f32 v232, v232, s100, -v236
  v_fma_f32 v229, v229, s100, -v237
  v_fma_f32 v233, v233, s100, -v237
  v_fma_f32 v230, v230, s100, -v238
  v_fma_f32 v234, v234, s100, -v238
  v_fma_f32 v231, v231, s100, -v239
  v_fma_f32 v235, v235, s100, -v239
  v_exp_f32 v228, v228
  v_exp_f32 v232, v232
  v_exp_f32 v229, v229
  v_exp_f32 v233, v233
  v_exp_f32 v230, v230
  v_exp_f32 v234, v234
  v_exp_f32 v231, v231
  v_exp_f32 v235, v235
  s_nop 0
  v_add_f32 v236, v228, v232
  v_add_f32 v237, v229, v233
  v_add_f32 v238, v230, v234
  v_add_f32 v239, v231, v235
  v_mov_b32 v240, v236
  v_mov_b32 v241, v237
  v_mov_b32 v242, v238
  v_mov_b32 v243, v239
  v_permlane32_swap_b32 v236, v240
  v_permlane32_swap_b32 v237, v241
  v_permlane32_swap_b32 v238, v242
  v_permlane32_swap_b32 v239, v243
  v_add_f32 v236, v236, v240
  v_add_f32 v237, v237, v241
  v_add_f32 v238, v238, v242
  v_add_f32 v239, v239, v243
  v_mov_b32 v240, v236
  v_mov_b32 v241, v237
  v_mov_b32 v242, v238
  v_mov_b32 v243, v239
  v_permlane16_swap_b32 v236, v240
  v_permlane16_swap_b32 v237, v241
  v_permlane16_swap_b32 v238, v242
  v_permlane16_swap_b32 v239, v243
  v_add_f32 v236, v236, v240
  v_add_f32 v237, v237, v241
  v_add_f32 v238, v238, v242
  v_add_f32 v239, v239, v243
  v_rcp_f32 v236, v236
  v_rcp_f32 v237, v237
  v_rcp_f32 v238, v238
  v_rcp_f32 v239, v239
  s_nop 0
  v_mul_f32 v228, v228, v236
  v_mul_f32 v232, v232, v236
  v_mul_f32 v229, v229, v237
  v_mul_f32 v233, v233, v237
  v_mul_f32 v230, v230, v238
  v_mul_f32 v234, v234, v238
  v_mul_f32 v231, v231, v239
  v_mul_f32 v235, v235, v239
  v_cvt_pk_bf16_f32 v228, v228, v228
  v_cvt_pk_bf16_f32 v232, v232, v232
  v_cvt_pk_bf16_f32 v229, v229, v229
  v_cvt_pk_bf16_f32 v233, v233, v233
  v_cvt_pk_bf16_f32 v230, v230, v230
  v_cvt_pk_bf16_f32 v234, v234, v234
  v_cvt_pk_bf16_f32 v231, v231, v231
  v_cvt_pk_bf16_f32 v235, v235, v235
  v_and_b32 v196, v228, v89
  v_and_b32 v197, v232, v90
  v_and_b32 v198, v228, v91
  v_and_b32 v199, v232, v92
  v_and_b32 v200, v229, v89
  v_and_b32 v201, v233, v90
  v_and_b32 v202, v229, v91
  v_and_b32 v203, v233, v92
  v_and_b32 v204, v230, v89
  v_and_b32 v205, v234, v90
  v_and_b32 v206, v230, v91
  v_and_b32 v207, v234, v92
  v_and_b32 v208, v231, v89
  v_and_b32 v209, v235, v90
  v_and_b32 v210, v231, v91
  v_and_b32 v211, v235, v92
  s_nop 1
  v_mfma_f32_16x16x32_bf16 v[212:215], v[184:187], v[196:199], 0
  v_mfma_f32_16x16x32_bf16 v[216:219], v[186:189], v[200:203], 0
  v_mfma_f32_16x16x32_bf16 v[220:223], v[188:191], v[204:207], 0
  v_mfma_f32_16x16x32_bf16 v[224:227], v[190:193], v[208:211], 0
  v_mul_u32_u24 v93, 144, v1
  v_lshl_add_u32 v93, v2, 3, v93
  s_lshl_b32 s61, s52, 5
  s_add_u32 s61, s61, 70656
  v_add_u32 v93, s61, v93
  s_lshl_b32 s61, s52, 3
  v_lshrrev_b32 v94, 3, v0
  v_add_u32 v94, s61, v94
  v_and_b32 v95, 7, v0
  v_lshlrev_b32 v95, 4, v95
  v_cvt_pk_bf16_f32 v212, v212, v213
  v_cvt_pk_bf16_f32 v213, v214, v215
  ds_write_b64 v93, v[212:213] offset:0
  v_cvt_pk_bf16_f32 v216, v216, v217
  v_cvt_pk_bf16_f32 v217, v218, v219
  ds_write_b64 v93, v[216:217] offset:2304
  v_cvt_pk_bf16_f32 v220, v220, v221
  v_cvt_pk_bf16_f32 v221, v222, v223
  ds_write_b64 v93, v[220:221] offset:4608
  v_cvt_pk_bf16_f32 v224, v224, v225
  v_cvt_pk_bf16_f32 v225, v226, v227
  ds_write_b64 v93, v[224:225] offset:6912
  v_mul_u32_u24 v96, 144, v94
  v_add3_u32 v96, v96, v95, 0
  v_add_u32 v96, 70656, v96
  v_lshl_add_u32 v97, v94, 7, v95
  s_lshl_b32 s61, s65, 10
  s_lshl_b32 s62, s54, 13
  s_add_u32 s61, s61, s62
  s_add_u32 s62, s61, 4096
  s_waitcnt lgkmcnt(0)
  s_barrier
  ds_read_b128 v[196:199], v96
  ds_read_b128 v[200:203], v96 offset:4608
  s_waitcnt lgkmcnt(1)
  buffer_store_dwordx4 v[196:199], v97, s[44:47], s61 offen sc1
  s_waitcnt lgkmcnt(0)
  buffer_store_dwordx4 v[200:203], v97, s[44:47], s62 offen sc1
  s_barrier
  s_and_b32 s65, s52, 1
  s_lshr_b32 s66, s52, 1
  v_and_b32 v1, 31, v0
  v_lshrrev_b32 v2, 5, v0
  v_bfe_u32 v3, v0, 3, 1
  v_xor_b32 v3, s66, v3
  v_lshlrev_b32 v3, 6, v3
  v_bfe_u32 v4, v0, 4, 1
  v_lshl_add_u32 v3, v4, 5, v3
  v_and_b32 v4, 3, v0
  v_lshl_add_u32 v3, v4, 3, v3
  v_bfe_u32 v4, v0, 2, 2
  v_lshl_add_u32 v3, v4, 7, v3
  v_lshl_add_u32 v232, v2, 10, v3
  v_add_u32 v5, 0, v232
  ds_read_b64_tr_b16 v[36:37], v5 offset:0
  ds_read_b64_tr_b16 v[38:39], v5 offset:512
  ds_read_b64_tr_b16 v[40:41], v5 offset:2048
  ds_read_b64_tr_b16 v[42:43], v5 offset:2560
  ds_read_b64_tr_b16 v[44:45], v5 offset:4096
  ds_read_b64_tr_b16 v[46:47], v5 offset:4608
  ds_read_b64_tr_b16 v[48:49], v5 offset:6144
  ds_read_b64_tr_b16 v[50:51], v5 offset:6656
  s_waitcnt lgkmcnt(4)
  ds_read_b64_tr_b16 v[52:53], v5 offset:8192
  ds_read_b64_tr_b16 v[54:55], v5 offset:8704
  ds_read_b64_tr_b16 v[56:57], v5 offset:10240
  ds_read_b64_tr_b16 v[58:59], v5 offset:10752
  ds_read_b64_tr_b16 v[60:61], v5 offset:12288
  ds_read_b64_tr_b16 v[62:63], v5 offset:12800
  ds_read_b64_tr_b16 v[64:65], v5 offset:14336
  ds_read_b64_tr_b16 v[66:67], v5 offset:14848
  s_waitcnt lgkmcnt(4)
  ds_read_b64_tr_b16 v[68:69], v5 offset:16384
  ds_read_b64_tr_b16 v[70:71], v5 offset:16896
  ds_read_b64_tr_b16 v[72:73], v5 offset:18432
  ds_read_b64_tr_b16 v[74:75], v5 offset:18944
  ds_read_b64_tr_b16 v[76:77], v5 offset:20480
  ds_read_b64_tr_b16 v[78:79], v5 offset:20992
  ds_read_b64_tr_b16 v[80:81], v5 offset:22528
  ds_read_b64_tr_b16 v[82:83], v5 offset:23040
  s_waitcnt lgkmcnt(4)
  s_waitcnt vmcnt(0)
  s_barrier
  ds_read_b64_tr_b16 v[84:85], v5 offset:24576
  ds_read_b64_tr_b16 v[86:87], v5 offset:25088
  ds_read_b64_tr_b16 v[88:89], v5 offset:26624
  ds_read_b64_tr_b16 v[90:91], v5 offset:27136
  ds_read_b64_tr_b16 v[92:93], v5 offset:28672
  ds_read_b64_tr_b16 v[94:95], v5 offset:29184
  ds_read_b64_tr_b16 v[96:97], v5 offset:30720
  ds_read_b64_tr_b16 v[98:99], v5 offset:31232
  s_waitcnt lgkmcnt(4)
  ds_read_b64_tr_b16 v[100:101], v5 offset:32768
  ds_read_b64_tr_b16 v[102:103], v5 offset:33280
  ds_read_b64_tr_b16 v[104:105], v5 offset:34816
  ds_read_b64_tr_b16 v[106:107], v5 offset:35328
  ds_read_b64_tr_b16 v[108:109], v5 offset:36864
  ds_read_b64_tr_b16 v[110:111], v5 offset:37376
  ds_read_b64_tr_b16 v[112:113], v5 offset:38912
  ds_read_b64_tr_b16 v[114:115], v5 offset:39424
  s_waitcnt lgkmcnt(4)
  ds_read_b64_tr_b16 v[116:117], v5 offset:40960
  ds_read_b64_tr_b16 v[118:119], v5 offset:41472
  ds_read_b64_tr_b16 v[120:121], v5 offset:43008
  ds_read_b64_tr_b16 v[122:123], v5 offset:43520
  ds_read_b64_tr_b16 v[124:125], v5 offset:45056
  ds_read_b64_tr_b16 v[126:127], v5 offset:45568
  ds_read_b64_tr_b16 v[128:129], v5 offset:47104
  ds_read_b64_tr_b16 v[130:131], v5 offset:47616
  s_waitcnt lgkmcnt(4)
  ds_read_b64_tr_b16 v[132:133], v5 offset:49152
  ds_read_b64_tr_b16 v[134:135], v5 offset:49664
  ds_read_b64_tr_b16 v[136:137], v5 offset:51200
  ds_read_b64_tr_b16 v[138:139], v5 offset:51712
  ds_read_b64_tr_b16 v[140:141], v5 offset:53248
  ds_read_b64_tr_b16 v[142:143], v5 offset:53760
  ds_read_b64_tr_b16 v[144:145], v5 offset:55296
  ds_read_b64_tr_b16 v[146:147], v5 offset:55808
  s_waitcnt lgkmcnt(4)
  ds_read_b64_tr_b16 v[148:149], v5 offset:57344
  ds_read_b64_tr_b16 v[150:151], v5 offset:57856
  ds_read_b64_tr_b16 v[152:153], v5 offset:59392
  ds_read_b64_tr_b16 v[154:155], v5 offset:59904
  ds_read_b64_tr_b16 v[156:157], v5 offset:61440
  ds_read_b64_tr_b16 v[158:159], v5 offset:61952
  ds_read_b64_tr_b16 v[160:161], v5 offset:63488
  ds_read_b64_tr_b16 v[162:163], v5 offset:64000
  s_waitcnt lgkmcnt(4)
  s_cmp_lg_u32 s52, 0
  s_cbranch_scc1 p1_done
  s_lshl_b32 s61, s55, 12
  s_add_u32 s61, s61, 15073280
  s_xor_b32 s61, s61, 0
  s_mov_b32 s64, 32768
tag_3:
  v_readfirstlane_b32 s22, v8
  v_readfirstlane_b32 s23, v9
  s_nop 1
  s_cmp_lg_u32 s22, 0
  s_cbranch_scc1 tagd_4
  v_mov_b32 v3, 0
  global_load_dwordx2 v[8:9], v3, s[32:33] sc1
  s_waitcnt vmcnt(0)
  s_sub_u32 s64, s64, 1
  s_cbranch_scc0 tag_3
tagd_4:
  s_nop 4
  v_min_u32 v3, 7, v0
  v_lshlrev_b32 v3, 7, v3
  s_mov_b32 s64, 32768
  s_mov_b64 s[62:63], -1
poll_5:
  buffer_load_dwordx2 v[8:9], v3, s[44:47], s61 offen sc1
  s_waitcnt vmcnt(0)
  v_cmp_ne_u64 vcc, s[22:23], v[8:9]
  s_nop 1
  s_and_b64 s[62:63], s[62:63], vcc
  s_cbranch_scc0 polld_6
  s_sub_u32 s64, s64, 1
  s_cbranch_scc1 polld_6
  s_cmp_gt_u32 s64, 32744
  s_cbranch_scc1 poll_5
  buffer_load_dwordx2 v[8:9], v3, s[44:47], s61 offen offset:2048 sc1
  s_waitcnt vmcnt(0)
  v_cmp_ne_u64 vcc, s[22:23], v[8:9]
  s_nop 1
  s_and_b64 s[62:63], s[62:63], vcc
  s_cbranch_scc0 polld_6
  s_branch poll_5
polld_6:
p1_done:
  s_barrier
  s_mov_b32 s48, s16
  s_mov_b32 s49, s17
  s_mov_b32 s50, 2097152
  s_mov_b32 s51, 0x20000
  v_lshrrev_b32 v3, 3, v0
  s_lshl_b32 s61, s52, 4
  v_add_u32 v3, s61, v3
  v_and_b32 v4, 7, v0
  v_lshlrev_b32 v4, 4, v4
  v_lshl_add_u32 v233, v3, 10, v4
  v_mul_u32_u24 v235, 144, v3
  v_add_u32 v235, v235, v4
  s_lshl_b32 s67, s55, 16
  s_lshl_b32 s61, s56, 7
  s_add_u32 s67, s67, s61
  s_add_u32 s61, s67, 8192
  buffer_load_dwordx4 v[28:31], v233, s[48:51], s67 offen
  buffer_load_dwordx4 v[32:35], v233, s[48:51], s61 offen
  v_bfe_u32 v3, v1, 1, 3
  v_xor_b32 v3, v3, v2
  v_lshlrev_b32 v3, 4, v3
  v_lshl_add_u32 v3, v1, 7, v3
  s_lshl_b32 s61, s65, 12
  s_add_u32 s61, s61, 98304
  v_add_u32 v228, s61, v3
  v_xor_b32 v229, 32, v228
  v_xor_b32 v230, 64, v228
  v_xor_b32 v231, 96, v228
  s_lshl_b32 s61, s65, 5
  v_add_u32 v3, s61, v1
  v_mul_u32_u24 v234, 144, v3
  v_lshl_add_u32 v234, v2, 3, v234
  s_lshl_b32 s61, s66, 6
  v_add_u32 v234, s61, v234
  v_mov_b32 v12, 0
  v_mov_b32 v13, 0
  v_mov_b32 v14, 0
  v_mov_b32 v15, 0
  v_mov_b32 v16, 0
  v_mov_b32 v17, 0
  v_mov_b32 v18, 0
  v_mov_b32 v19, 0
  v_mov_b32 v20, 0
  v_mov_b32 v21, 0
  v_mov_b32 v22, 0
  v_mov_b32 v23, 0
  v_mov_b32 v24, 0
  v_mov_b32 v25, 0
  v_mov_b32 v26, 0
  v_mov_b32 v27, 0
  s_waitcnt lgkmcnt(0)
  s_barrier
  ds_read_b128 v[164:167], v228 offset:0
  ds_read_b128 v[168:171], v229 offset:0
  ds_read_b128 v[172:175], v230 offset:0
  ds_read_b128 v[176:179], v231 offset:0
  ds_read_b128 v[180:183], v228 offset:8192
  ds_read_b128 v[184:187], v229 offset:8192
  ds_read_b128 v[188:191], v230 offset:8192
  ds_read_b128 v[192:195], v231 offset:8192
  s_waitcnt lgkmcnt(7)
  v_mfma_f32_32x32x16_bf16 v[12:27], v[36:39], v[164:167], v[12:27]
  s_waitcnt lgkmcnt(0)
  s_barrier
  v_mfma_f32_32x32x16_bf16 v[12:27], v[40:43], v[168:171], v[12:27]
  ds_read_b128 v[196:199], v228 offset:16384
  ds_read_b128 v[200:203], v229 offset:16384
  v_mfma_f32_32x32x16_bf16 v[12:27], v[44:47], v[172:175], v[12:27]
  ds_read_b128 v[204:207], v230 offset:16384
  ds_read_b128 v[208:211], v231 offset:16384
  v_mfma_f32_32x32x16_bf16 v[12:27], v[48:51], v[176:179], v[12:27]
  ds_read_b128 v[212:215], v228 offset:24576
  ds_read_b128 v[216:219], v229 offset:24576
  v_mfma_f32_32x32x16_bf16 v[12:27], v[52:55], v[180:183], v[12:27]
  ds_read_b128 v[220:223], v230 offset:24576
  ds_read_b128 v[224:227], v231 offset:24576
  v_mfma_f32_32x32x16_bf16 v[12:27], v[56:59], v[184:187], v[12:27]
  v_mfma_f32_32x32x16_bf16 v[12:27], v[60:63], v[188:191], v[12:27]
  v_mfma_f32_32x32x16_bf16 v[12:27], v[64:67], v[192:195], v[12:27]
  s_waitcnt lgkmcnt(0)
  v_mfma_f32_32x32x16_bf16 v[12:27], v[68:71], v[196:199], v[12:27]
  s_barrier
  v_mfma_f32_32x32x16_bf16 v[12:27], v[72:75], v[200:203], v[12:27]
  ds_read_b128 v[164:167], v228 offset:32768
  ds_read_b128 v[168:171], v229 offset:32768
  v_mfma_f32_32x32x16_bf16 v[12:27], v[76:79], v[204:207], v[12:27]
  ds_read_b128 v[172:175], v230 offset:32768
  ds_read_b128 v[176:179], v231 offset:32768
  v_mfma_f32_32x32x16_bf16 v[12:27], v[80:83], v[208:211], v[12:27]
  ds_read_b128 v[180:183], v228 offset:40960
  ds_read_b128 v[184:187], v229 offset:40960
  v_mfma_f32_32x32x16_bf16 v[12:27], v[84:87], v[212:215], v[12:27]
  ds_read_b128 v[188:191], v230 offset:40960
  ds_read_b128 v[192:195], v231 offset:40960
  v_mfma_f32_32x32x16_bf16 v[12:27], v[88:91], v[216:219], v[12:27]
  v_mfma_f32_32x32x16_bf16 v[12:27], v[92:95], v[220:223], v[12:27]
  v_mfma_f32_32x32x16_bf16 v[12:27], v[96:99], v[224:227], v[12:27]
  s_waitcnt lgkmcnt(0)
  v_mfma_f32_32x32x16_bf16 v[12:27], v[100:103], v[164:167], v[12:27]
  s_barrier
  v_mfma_f32_32x32x16_bf16 v[12:27], v[104:107], v[168:171], v[12:27]
  ds_read_b128 v[196:199], v228 offset:49152
  ds_read_b128 v[200:203], v229 offset:49152
  v_mfma_f32_32x32x16_bf16 v[12:27], v[108:111], v[172:175], v[12:27]
  ds_read_b128 v[204:207], v230 offset:49152
  ds_read_b128 v[208:211], v231 offset:49152
  v_mfma_f32_32x32x16_bf16 v[12:27], v[112:115], v[176:179], v[12:27]
  ds_read_b128 v[212:215], v228 offset:57344
  ds_read_b128 v[216:219], v229 offset:57344
  v_mfma_f32_32x32x16_bf16 v[12:27], v[116:119], v[180:183], v[12:27]
  ds_read_b128 v[220:223], v230 offset:57344
  ds_read_b128 v[224:227], v231 offset:57344
  v_mfma_f32_32x32x16_bf16 v[12:27], v[120:123], v[184:187], v[12:27]
  v_mfma_f32_32x32x16_bf16 v[12:27], v[124:127], v[188:191], v[12:27]
  v_mfma_f32_32x32x16_bf16 v[12:27], v[128:131], v[192:195], v[12:27]
  s_waitcnt lgkmcnt(0)
  v_mfma_f32_32x32x16_bf16 v[12:27], v[132:135], v[196:199], v[12:27]
  v_mfma_f32_32x32x16_bf16 v[12:27], v[136:139], v[200:203], v[12:27]
  v_mfma_f32_32x32x16_bf16 v[12:27], v[140:143], v[204:207], v[12:27]
  v_mfma_f32_32x32x16_bf16 v[12:27], v[144:147], v[208:211], v[12:27]
  v_mfma_f32_32x32x16_bf16 v[12:27], v[148:151], v[212:215], v[12:27]
  v_mfma_f32_32x32x16_bf16 v[12:27], v[152:155], v[216:219], v[12:27]
  v_mfma_f32_32x32x16_bf16 v[12:27], v[156:159], v[220:223], v[12:27]
  v_mfma_f32_32x32x16_bf16 v[12:27], v[160:163], v[224:227], v[12:27]
  s_nop 7
  s_nop 3
  v_cvt_pk_bf16_f32 v164, v12, v13
  v_cvt_pk_bf16_f32 v165, v14, v15
  ds_write_b64 v234, v[164:165] offset:0
  v_cvt_pk_bf16_f32 v166, v16, v17
  v_cvt_pk_bf16_f32 v167, v18, v19
  ds_write_b64 v234, v[166:167] offset:16
  v_cvt_pk_bf16_f32 v168, v20, v21
  v_cvt_pk_bf16_f32 v169, v22, v23
  ds_write_b64 v234, v[168:169] offset:32
  v_cvt_pk_bf16_f32 v170, v24, v25
  v_cvt_pk_bf16_f32 v171, v26, v27
  ds_write_b64 v234, v[170:171] offset:48
  s_waitcnt lgkmcnt(0)
  s_barrier
  ds_read_b128 v[172:175], v235
  ds_read_b128 v[176:179], v235 offset:1152
  s_lshl_b32 s67, s55, 3
  s_add_u32 s67, s67, s56
  s_lshl_b32 s67, s67, 2
  s_add_u32 s67, s67, s52
  s_lshl_b32 s67, s67, 11
  s_add_u32 s67, s67, 2097152
  s_add_u32 s61, s67, 1024
  v_lshlrev_b32 v233, 4, v0
  v_mov_b32 v200, 0x3f803f80
  v_mov_b32 v204, 0
  v_mov_b32 v205, 0
  v_mov_b32 v206, 0
  v_mov_b32 v207, 0
  s_waitcnt vmcnt(0) lgkmcnt(0)
  v_lshlrev_b32 v196, 16, v172
  v_and_b32 v197, 0xffff0000, v172
  v_lshlrev_b32 v198, 16, v28
  v_and_b32 v199, 0xffff0000, v28
  v_add_f32 v196, v196, v198
  v_add_f32 v197, v197, v199
  v_cvt_pk_bf16_f32 v248, v196, v197
  v_lshlrev_b32 v196, 16, v173
  v_and_b32 v197, 0xffff0000, v173
  v_lshlrev_b32 v198, 16, v29
  v_and_b32 v199, 0xffff0000, v29
  v_add_f32 v196, v196, v198
  v_add_f32 v197, v197, v199
  v_cvt_pk_bf16_f32 v249, v196, v197
  v_lshlrev_b32 v196, 16, v174
  v_and_b32 v197, 0xffff0000, v174
  v_lshlrev_b32 v198, 16, v30
  v_and_b32 v199, 0xffff0000, v30
  v_add_f32 v196, v196, v198
  v_add_f32 v197, v197, v199
  v_cvt_pk_bf16_f32 v250, v196, v197
  v_lshlrev_b32 v196, 16, v175
  v_and_b32 v197, 0xffff0000, v175
  v_lshlrev_b32 v198, 16, v31
  v_and_b32 v199, 0xffff0000, v31
  v_add_f32 v196, v196, v198
  v_add_f32 v197, v197, v199
  v_cvt_pk_bf16_f32 v251, v196, v197
  v_lshlrev_b32 v196, 16, v176
  v_and_b32 v197, 0xffff0000, v176
  v_lshlrev_b32 v198, 16, v32
  v_and_b32 v199, 0xffff0000, v32
  v_add_f32 v196, v196, v198
  v_add_f32 v197, v197, v199
  v_cvt_pk_bf16_f32 v252, v196, v197
  v_lshlrev_b32 v196, 16, v177
  v_and_b32 v197, 0xffff0000, v177
  v_lshlrev_b32 v198, 16, v33
  v_and_b32 v199, 0xffff0000, v33
  v_add_f32 v196, v196, v198
  v_add_f32 v197, v197, v199
  v_cvt_pk_bf16_f32 v253, v196, v197
  v_lshlrev_b32 v196, 16, v178
  v_and_b32 v197, 0xffff0000, v178
  v_lshlrev_b32 v198, 16, v34
  v_and_b32 v199, 0xffff0000, v34
  v_add_f32 v196, v196, v198
  v_add_f32 v197, v197, v199
  v_cvt_pk_bf16_f32 v254, v196, v197
  v_lshlrev_b32 v196, 16, v179
  v_and_b32 v197, 0xffff0000, v179
  v_lshlrev_b32 v198, 16, v35
  v_and_b32 v199, 0xffff0000, v35
  v_add_f32 v196, v196, v198
  v_add_f32 v197, v197, v199
  v_cvt_pk_bf16_f32 v255, v196, v197
  buffer_store_dwordx4 v[248:251], v233, s[44:47], s67 offen sc1
  buffer_store_dwordx4 v[252:255], v233, s[44:47], s61 offen sc1
  v_dot2c_f32_bf16 v204, v248, v200
  v_dot2c_f32_bf16 v205, v248, v248
  v_dot2c_f32_bf16 v204, v249, v200
  v_dot2c_f32_bf16 v205, v249, v249
  v_dot2c_f32_bf16 v204, v250, v200
  v_dot2c_f32_bf16 v205, v250, v250
  v_dot2c_f32_bf16 v204, v251, v200
  v_dot2c_f32_bf16 v205, v251, v251
  v_dot2c_f32_bf16 v206, v252, v200
  v_dot2c_f32_bf16 v207, v252, v252
  v_dot2c_f32_bf16 v206, v253, v200
  v_dot2c_f32_bf16 v207, v253, v253
  v_dot2c_f32_bf16 v206, v254, v200
  v_dot2c_f32_bf16 v207, v254, v254
  v_dot2c_f32_bf16 v206, v255, v200
  v_dot2c_f32_bf16 v207, v255, v255
  s_nop 1
  v_add_f32_dpp v204, v204, v204 quad_perm:[1,0,3,2] row_mask:0xf bank_mask:0xf
  v_add_f32_dpp v205, v205, v205 quad_perm:[1,0,3,2] row_mask:0xf bank_mask:0xf
  v_add_f32_dpp v206, v206, v206 quad_perm:[1,0,3,2] row_mask:0xf bank_mask:0xf
  v_add_f32_dpp v207, v207, v207 quad_perm:[1,0,3,2] row_mask:0xf bank_mask:0xf
  v_add_f32_dpp v204, v204, v204 quad_perm:[2,3,0,1] row_mask:0xf bank_mask:0xf
  v_add_f32_dpp v205, v205, v205 quad_perm:[2,3,0,1] row_mask:0xf bank_mask:0xf
  v_add_f32_dpp v206, v206, v206 quad_perm:[2,3,0,1] row_mask:0xf bank_mask:0xf
  v_add_f32_dpp v207, v207, v207 quad_perm:[2,3,0,1] row_mask:0xf bank_mask:0xf
  v_add_f32_dpp v204, v204, v204 row_half_mirror row_mask:0xf bank_mask:0xf
  v_add_f32_dpp v205, v205, v205 row_half_mirror row_mask:0xf bank_mask:0xf
  v_add_f32_dpp v206, v206, v206 row_half_mirror row_mask:0xf bank_mask:0xf
  v_add_f32_dpp v207, v207, v207 row_half_mirror row_mask:0xf bank_mask:0xf
  v_lshrrev_b32 v3, 3, v0
  v_lshlrev_b32 v3, 3, v3
  s_lshl_b32 s61, s52, 7
  s_add_u32 s61, s61, 9216
  v_add_u32 v3, s61, v3
  v_lshl_add_u32 v4, v0, 4, s61
  s_mov_b32 exec_lo, 0x01010101
  s_mov_b32 exec_hi, 0x01010101
  ds_write_b64 v3, v[204:205]
  ds_write_b64 v3, v[206:207] offset:64
  s_mov_b64 exec, 0xff
  s_waitcnt lgkmcnt(0)
  ds_read_b128 v[208:211], v4
  v_lshlrev_b32 v3, 4, v0
  s_lshl_b32 s61, s56, 14
  s_lshl_b32 s62, s55, 9
  s_add_u32 s61, s61, s62
  s_lshl_b32 s62, s52, 7
  s_add_u32 s61, s61, s62
  s_add_u32 s61, s61, 12582912
  s_waitcnt lgkmcnt(0)
  buffer_store_dwordx4 v[208:211], v3, s[44:47], s61 offen sc1
  s_mov_b64 exec, -1
  s_waitcnt vmcnt(0)
  s_barrier
  s_cmp_ge_u32 s58, 14
  s_cbranch_scc1 s3_idle
  s_cmp_lg_u32 s52, 0
  s_cbranch_scc1 p2_done
  s_lshl_b32 s61, s57, 12
  s_add_u32 s61, s61, 14942208
  s_xor_b32 s61, s61, 0
  v_min_u32 v3, 15, v0
  v_lshlrev_b32 v3, 7, v3
  s_mov_b32 s64, 32768
  s_mov_b64 s[62:63], -1
poll_7:
  buffer_load_dwordx2 v[8:9], v3, s[44:47], s61 offen sc1
  s_waitcnt vmcnt(0)
  v_cmp_ne_u64 vcc, s[22:23], v[8:9]
  s_nop 1
  s_and_b64 s[62:63], s[62:63], vcc
  s_cbranch_scc0 polld_8
  s_sub_u32 s64, s64, 1
  s_cbranch_scc1 polld_8
  s_cmp_gt_u32 s64, 32744
  s_cbranch_scc1 poll_7
  buffer_load_dwordx2 v[8:9], v3, s[44:47], s61 offen offset:2048 sc1
  s_waitcnt vmcnt(0)
  v_cmp_ne_u64 vcc, s[22:23], v[8:9]
  s_nop 1
  s_and_b64 s[62:63], s[62:63], vcc
  s_cbranch_scc0 polld_8
  s_branch poll_7
polld_8:
p2_done:
  s_barrier
  v_bfe_u32 v3, v1, 1, 3
  v_xor_b32 v3, v3, v2
  v_lshlrev_b32 v3, 4, v3
  v_lshl_add_u32 v3, v1, 7, v3
  s_lshl_b32 s61, s65, 13
  v_add_u32 v220, s61, v3
  v_xor_b32 v221, 32, v220
  v_xor_b32 v222, 64, v220
  v_xor_b32 v223, 96, v220
  v_bfe_u32 v4, v0, 2, 2
  s_lshl_b32 s61, s66, 1
  v_xor_b32 v3, s61, v4
  v_lshlrev_b32 v3, 6, v3
  v_lshl_add_u32 v3, v4, 8, v3
  v_bfe_u32 v4, v0, 4, 1
  v_lshl_add_u32 v3, v4, 5, v3
  v_and_b32 v4, 3, v0
  v_lshl_add_u32 v3, v4, 3, v3
  v_lshl_add_u32 v3, v2, 11, v3
  v_add_u32 v224, 65536, v3
  v_xor_b32 v225, 64, v224
  s_mov_b32 s67, 0
  s_mov_b32 s69, 0
  s_mov_b32 s68, 0
  v_mov_b32 v226, v220
  v_mov_b32 v227, v221
  v_mov_b32 v228, v222
  v_mov_b32 v229, v223
  v_mov_b32 v230, v224
  v_mov_b32 v231, v225
  v_mov_b32 v12, 0
  v_mov_b32 v13, 0
  v_mov_b32 v14, 0
  v_mov_b32 v15, 0
  v_mov_b32 v16, 0
  v_mov_b32 v17, 0
  v_mov_b32 v18, 0
  v_mov_b32 v19, 0
  v_mov_b32 v20, 0
  v_mov_b32 v21, 0
  v_mov_b32 v22, 0
  v_mov_b32 v23, 0
  v_mov_b32 v24, 0
  v_mov_b32 v25, 0
  v_mov_b32 v26, 0
  v_mov_b32 v27, 0
  v_mov_b32 v28, 0
  v_mov_b32 v29, 0
  v_mov_b32 v30, 0
  v_mov_b32 v31, 0
  v_mov_b32 v32, 0
  v_mov_b32 v33, 0
  v_mov_b32 v34, 0
  v_mov_b32 v35, 0
  v_mov_b32 v36, 0
  v_mov_b32 v37, 0
  v_mov_b32 v38, 0
  v_mov_b32 v39, 0
  v_mov_b32 v40, 0
  v_mov_b32 v41, 0
  v_mov_b32 v42, 0
  v_mov_b32 v43, 0
  v_mov_b32 v44, 0
  v_mov_b32 v45, 0
  v_mov_b32 v46, 0
  v_mov_b32 v47, 0
  v_mov_b32 v48, 0
  v_mov_b32 v49, 0
  v_mov_b32 v50, 0
  v_mov_b32 v51, 0
  v_mov_b32 v52, 0
  v_mov_b32 v53, 0
  v_mov_b32 v54, 0
  v_mov_b32 v55, 0
  v_mov_b32 v56, 0
  v_mov_b32 v57, 0
  v_mov_b32 v58, 0
  v_mov_b32 v59, 0
  v_mov_b32 v60, 0
  v_mov_b32 v61, 0
  v_mov_b32 v62, 0
  v_mov_b32 v63, 0
  v_mov_b32 v64, 0
  v_mov_b32 v65, 0
  v_mov_b32 v66, 0
  v_mov_b32 v67, 0
  v_mov_b32 v68, 0
  v_mov_b32 v69, 0
  v_mov_b32 v70, 0
  v_mov_b32 v71, 0
  v_mov_b32 v72, 0
  v_mov_b32 v73, 0
  v_mov_b32 v74, 0
  v_mov_b32 v75, 0
  v_mov_b32 v76, 0
  v_mov_b32 v77, 0
  v_mov_b32 v78, 0
  v_mov_b32 v79, 0
  v_mov_b32 v80, 0
  v_mov_b32 v81, 0
  v_mov_b32 v82, 0
  v_mov_b32 v83, 0
  v_mov_b32 v84, 0
  v_mov_b32 v85, 0
  v_mov_b32 v86, 0
  v_mov_b32 v87, 0
  v_mov_b32 v88, 0
  v_mov_b32 v89, 0
  v_mov_b32 v90, 0
  v_mov_b32 v91, 0
  v_mov_b32 v92, 0
  v_mov_b32 v93, 0
  v_mov_b32 v94, 0
  v_mov_b32 v95, 0
  v_mov_b32 v96, 0
  v_mov_b32 v97, 0
  v_mov_b32 v98, 0
  v_mov_b32 v99, 0
  v_mov_b32 v100, 0
  v_mov_b32 v101, 0
  v_mov_b32 v102, 0
  v_mov_b32 v103, 0
  v_mov_b32 v104, 0
  v_mov_b32 v105, 0
  v_mov_b32 v106, 0
  v_mov_b32 v107, 0
  v_mov_b32 v108, 0
  v_mov_b32 v109, 0
  v_mov_b32 v110, 0
  v_mov_b32 v111, 0
  v_mov_b32 v112, 0
  v_mov_b32 v113, 0
  v_mov_b32 v114, 0
  v_mov_b32 v115, 0
  v_mov_b32 v116, 0
  v_mov_b32 v117, 0
  v_mov_b32 v118, 0
  v_mov_b32 v119, 0
  v_mov_b32 v120, 0
  v_mov_b32 v121, 0
  v_mov_b32 v122, 0
  v_mov_b32 v123, 0
  v_mov_b32 v124, 0
  v_mov_b32 v125, 0
  v_mov_b32 v126, 0
  v_mov_b32 v127, 0
  v_mov_b32 v128, 0
  v_mov_b32 v129, 0
  v_mov_b32 v130, 0
  v_mov_b32 v131, 0
  v_mov_b32 v132, 0
  v_mov_b32 v133, 0
  v_mov_b32 v134, 0
  v_mov_b32 v135, 0
  v_mov_b32 v136, 0
  v_mov_b32 v137, 0
  v_mov_b32 v138, 0
  v_mov_b32 v139, 0
  v_mov_b32 v206, 0
  v_mov_b32 v207, 0
  v_mov_b32 v210, 0
  v_mov_b32 v211, 0
  v_mov_b32 v190, 0
  v_mov_b32 v191, 0
  v_mov_b32 v194, 0
  v_mov_b32 v195, 0
  v_mov_b32 v198, 0
  v_mov_b32 v199, 0
  v_mov_b32 v202, 0
  v_mov_b32 v203, 0
  v_cmp_gt_u32 s[70:71], 32, v0
  s_barrier
  ds_read_b64_tr_b16 v[156:157], v230 offset:0
  ds_read_b64_tr_b16 v[158:159], v230 offset:1024
  ds_read_b128 v[140:143], v226 offset:0
  ds_read_b64_tr_b16 v[160:161], v231 offset:0
  ds_read_b64_tr_b16 v[162:163], v231 offset:1024
  ds_read_b128 v[144:147], v226 offset:4096
  ds_read_b64_tr_b16 v[164:165], v230 offset:16384
  ds_read_b64_tr_b16 v[166:167], v230 offset:17408
  ds_read_b64_tr_b16 v[168:169], v231 offset:16384
  ds_read_b64_tr_b16 v[170:171], v231 offset:17408
  s_lshr_b32 s61, s52, 1
  s_add_u32 s61, s61, 6
  s_cmp_ge_u32 s61, 8
  s_cbranch_scc1 pfs_9
  s_lshl_b32 s61, s61, 5
  s_add_u32 s61, s61, s59
  s_mul_i32 s61, s61, 7168
  s_bitcmp1_b32 s52, 0
  s_cbranch_scc1 pfs_9_u
  buffer_load_dword v7, v6, s[36:39], s61 offen
  s_branch pfs_9
pfs_9_u:
  buffer_load_dword v7, v6, s[40:43], s61 offen
pfs_9:
s3_loop:
  s_waitcnt lgkmcnt(0)
  v_mfma_f32_32x32x16_bf16 v[12:27], v[156:159], v[140:143], v[12:27]
  ds_read_b64_tr_b16 v[172:173], v230 offset:4096
  ds_read_b64_tr_b16 v[174:175], v230 offset:5120
  v_mfma_f32_32x32x16_bf16 v[28:43], v[156:159], v[144:147], v[28:43]
  ds_read_b128 v[148:151], v227 offset:0
  ds_read_b64_tr_b16 v[176:177], v231 offset:4096
  v_mfma_f32_32x32x16_bf16 v[44:59], v[160:163], v[140:143], v[44:59]
  ds_read_b64_tr_b16 v[178:179], v231 offset:5120
  ds_read_b128 v[152:155], v227 offset:4096
  v_mfma_f32_32x32x16_bf16 v[60:75], v[160:163], v[144:147], v[60:75]
  ds_read_b64_tr_b16 v[180:181], v230 offset:20480
  ds_read_b64_tr_b16 v[182:183], v230 offset:21504
  v_mfma_f32_32x32x16_bf16 v[76:91], v[164:167], v[140:143], v[76:91]
  ds_read_b64_tr_b16 v[184:185], v231 offset:20480
  ds_read_b64_tr_b16 v[186:187], v231 offset:21504
  v_mfma_f32_32x32x16_bf16 v[92:107], v[164:167], v[144:147], v[92:107]
  v_mfma_f32_32x32x16_bf16 v[108:123], v[168:171], v[140:143], v[108:123]
  v_mfma_f32_32x32x16_bf16 v[124:139], v[168:171], v[144:147], v[124:139]
  s_waitcnt lgkmcnt(0)
  v_mfma_f32_32x32x16_bf16 v[12:27], v[172:175], v[148:151], v[12:27]
  ds_read_b64_tr_b16 v[156:157], v230 offset:8192
  ds_read_b64_tr_b16 v[158:159], v230 offset:9216
  v_mfma_f32_32x32x16_bf16 v[28:43], v[172:175], v[152:155], v[28:43]
  ds_read_b128 v[140:143], v228 offset:0
  ds_read_b64_tr_b16 v[160:161], v231 offset:8192
  v_mfma_f32_32x32x16_bf16 v[44:59], v[176:179], v[148:151], v[44:59]
  ds_read_b64_tr_b16 v[162:163], v231 offset:9216
  ds_read_b128 v[144:147], v228 offset:4096
  v_mfma_f32_32x32x16_bf16 v[60:75], v[176:179], v[152:155], v[60:75]
  ds_read_b64_tr_b16 v[164:165], v230 offset:24576
  ds_read_b64_tr_b16 v[166:167], v230 offset:25600
  v_mfma_f32_32x32x16_bf16 v[76:91], v[180:183], v[148:151], v[76:91]
  ds_read_b64_tr_b16 v[168:169], v231 offset:24576
  ds_read_b64_tr_b16 v[170:171], v231 offset:25600
  v_mfma_f32_32x32x16_bf16 v[92:107], v[180:183], v[152:155], v[92:107]
  v_mfma_f32_32x32x16_bf16 v[108:123], v[184:187], v[148:151], v[108:123]
  v_mfma_f32_32x32x16_bf16 v[124:139], v[184:187], v[152:155], v[124:139]
  s_waitcnt lgkmcnt(0)
  v_mfma_f32_32x32x16_bf16 v[12:27], v[156:159], v[140:143], v[12:27]
  ds_read_b64_tr_b16 v[172:173], v230 offset:12288
  ds_read_b64_tr_b16 v[174:175], v230 offset:13312
  v_mfma_f32_32x32x16_bf16 v[28:43], v[156:159], v[144:147], v[28:43]
  ds_read_b128 v[148:151], v229 offset:0
  ds_read_b64_tr_b16 v[176:177], v231 offset:12288
  v_mfma_f32_32x32x16_bf16 v[44:59], v[160:163], v[140:143], v[44:59]
  ds_read_b64_tr_b16 v[178:179], v231 offset:13312
  ds_read_b128 v[152:155], v229 offset:4096
  v_mfma_f32_32x32x16_bf16 v[60:75], v[160:163], v[144:147], v[60:75]
  ds_read_b64_tr_b16 v[180:181], v230 offset:28672
  ds_read_b64_tr_b16 v[182:183], v230 offset:29696
  v_mfma_f32_32x32x16_bf16 v[76:91], v[164:167], v[140:143], v[76:91]
  ds_read_b64_tr_b16 v[184:185], v231 offset:28672
  ds_read_b64_tr_b16 v[186:187], v231 offset:29696
  v_mfma_f32_32x32x16_bf16 v[92:107], v[164:167], v[144:147], v[92:107]
  v_mfma_f32_32x32x16_bf16 v[108:123], v[168:171], v[140:143], v[108:123]
  v_mfma_f32_32x32x16_bf16 v[124:139], v[168:171], v[144:147], v[124:139]
  s_waitcnt lgkmcnt(0)
  v_mfma_f32_32x32x16_bf16 v[12:27], v[172:175], v[148:151], v[12:27]
  s_cmp_eq_u32 s68, 7
  s_cbranch_scc1 s3_last
  s_add_u32 s67, s67, 16384
  s_cmp_eq_u32 s67, 49152
  s_cselect_b32 s67, 0, s67
  s_lshl_b32 s69, s67, 1
  s_add_u32 s68, s68, 1
  v_add_u32 v230, s69, v224
  v_add_u32 v226, s67, v220
  v_add_u32 v231, s69, v225
  s_barrier
  v_mfma_f32_32x32x16_bf16 v[28:43], v[172:175], v[152:155], v[28:43]
  ds_read_b64_tr_b16 v[156:157], v230 offset:0
  ds_read_b64_tr_b16 v[158:159], v230 offset:1024
  v_mfma_f32_32x32x16_bf16 v[44:59], v[176:179], v[148:151], v[44:59]
  ds_read_b128 v[140:143], v226 offset:0
  ds_read_b64_tr_b16 v[160:161], v231 offset:0
  v_mfma_f32_32x32x16_bf16 v[60:75], v[176:179], v[152:155], v[60:75]
  ds_read_b64_tr_b16 v[162:163], v231 offset:1024
  ds_read_b128 v[144:147], v226 offset:4096
  v_mfma_f32_32x32x16_bf16 v[76:91], v[180:183], v[148:151], v[76:91]
  ds_read_b64_tr_b16 v[164:165], v230 offset:16384
  ds_read_b64_tr_b16 v[166:167], v230 offset:17408
  v_mfma_f32_32x32x16_bf16 v[92:107], v[180:183], v[152:155], v[92:107]
  ds_read_b64_tr_b16 v[168:169], v231 offset:16384
  ds_read_b64_tr_b16 v[170:171], v231 offset:17408
  v_mfma_f32_32x32x16_bf16 v[108:123], v[184:187], v[148:151], v[108:123]
  v_add_u32 v227, s67, v221
  v_add_u32 v228, s67, v222
  v_mfma_f32_32x32x16_bf16 v[124:139], v[184:187], v[152:155], v[124:139]
  v_add_u32 v229, s67, v223
  s_branch s3_loop
s3_last:
  s_barrier
  s_lshl_b32 s61, s65, 10
  s_add_u32 s61, s61, 49152
  v_lshl_add_u32 v3, v1, 4, s61
  ds_read_b128 v[212:215], v3
  ds_read_b128 v[216:219], v3 offset:512
  s_lshl_b32 s61, s66, 9
  s_add_u32 s61, s61, 51200
  v_lshl_add_u32 v3, v1, 3, s61
  ds_read_b64 v[188:189], v3 offset:0
  ds_read_b64 v[192:193], v3 offset:256
  ds_read_b64 v[196:197], v3 offset:1024
  ds_read_b64 v[200:201], v3 offset:1280
  v_mfma_f32_32x32x16_bf16 v[28:43], v[172:175], v[152:155], v[28:43]
  v_mul_u32_u24 v220, 144, v1
  v_lshl_add_u32 v220, v2, 3, v220
  s_mul_i32 s61, s52, 9216
  v_mfma_f32_32x32x16_bf16 v[44:59], v[176:179], v[148:151], v[44:59]
  v_add_u32 v220, s61, v220
  v_lshrrev_b32 v3, 3, v0
  v_and_b32 v4, 7, v0
  v_mfma_f32_32x32x16_bf16 v[60:75], v[176:179], v[152:155], v[60:75]
  v_lshlrev_b32 v4, 4, v4
  v_mul_u32_u24 v221, 144, v3
  v_add3_u32 v221, v221, v4, s61
  v_mfma_f32_32x32x16_bf16 v[76:91], v[180:183], v[148:151], v[76:91]
  v_mul_u32_u24 v222, 128, v3
  v_add_u32 v222, v222, v4
  s_waitcnt lgkmcnt(0)
  v_mfma_f32_32x32x16_bf16 v[92:107], v[180:183], v[152:155], v[92:107]
  v_cndmask_b32 v204, 0, v212, s[70:71]
  v_cndmask_b32 v205, 0, v213, s[70:71]
  v_cndmask_b32 v208, 0, v216, s[70:71]
  v_mfma_f32_32x32x16_bf16 v[108:123], v[184:187], v[148:151], v[108:123]
  v_cndmask_b32 v209, 0, v217, s[70:71]
  v_mfma_f32_32x32x16_bf16 v[124:139], v[184:187], v[152:155], v[124:139]
  v_mfma_f32_32x32x16_bf16 v[12:27], v[188:191], v[204:207], v[12:27]
  v_mfma_f32_32x32x16_bf16 v[76:91], v[196:199], v[204:207], v[76:91]
  v_mfma_f32_32x32x16_bf16 v[44:59], v[192:195], v[204:207], v[44:59]
  v_mfma_f32_32x32x16_bf16 v[108:123], v[200:203], v[204:207], v[108:123]
  v_mfma_f32_32x32x16_bf16 v[28:43], v[188:191], v[208:211], v[28:43]
  v_mfma_f32_32x32x16_bf16 v[92:107], v[196:199], v[208:211], v[92:107]
  v_mfma_f32_32x32x16_bf16 v[60:75], v[192:195], v[208:211], v[60:75]
  v_mfma_f32_32x32x16_bf16 v[124:139], v[200:203], v[208:211], v[124:139]
  s_lshl_b32 s72, s57, 1
  s_add_u32 s72, s72, s65
  s_mul_i32 s72, s72, 229376
  s_lshl_b32 s62, s58, 14
  s_add_u32 s72, s72, s62
  s_lshl_b32 s62, s66, 13
  s_add_u32 s72, s72, s62
  s_add_u32 s72, s72, 4194304
  v_pk_mul_f32 v[140:141], v[12:13], v[214:215] op_sel_hi:[1,0]
  v_pk_mul_f32 v[142:143], v[14:15], v[214:215] op_sel_hi:[1,0]
  v_pk_mul_f32 v[144:145], v[16:17], v[214:215] op_sel_hi:[1,0]
  v_pk_mul_f32 v[146:147], v[18:19], v[214:215] op_sel_hi:[1,0]
  v_pk_mul_f32 v[148:149], v[20:21], v[214:215] op_sel_hi:[1,0]
  v_pk_mul_f32 v[150:151], v[22:23], v[214:215] op_sel_hi:[1,0]
  v_pk_mul_f32 v[152:153], v[24:25], v[214:215] op_sel_hi:[1,0]
  v_pk_mul_f32 v[154:155], v[26:27], v[214:215] op_sel_hi:[1,0]
  v_exp_f32 v140, v140
  v_exp_f32 v141, v141
  v_pk_mul_f32 v[12:13], v[12:13], v[76:77]
  v_exp_f32 v142, v142
  v_exp_f32 v143, v143
  v_pk_mul_f32 v[14:15], v[14:15], v[78:79]
  v_exp_f32 v144, v144
  v_exp_f32 v145, v145
  v_pk_mul_f32 v[16:17], v[16:17], v[80:81]
  v_exp_f32 v146, v146
  v_exp_f32 v147, v147
  v_pk_mul_f32 v[18:19], v[18:19], v[82:83]
  v_exp_f32 v148, v148
  v_exp_f32 v149, v149
  v_pk_mul_f32 v[20:21], v[20:21], v[84:85]
  v_exp_f32 v150, v150
  v_exp_f32 v151, v151
  v_pk_mul_f32 v[22:23], v[22:23], v[86:87]
  v_exp_f32 v152, v152
  v_exp_f32 v153, v153
  v_pk_mul_f32 v[24:25], v[24:25], v[88:89]
  v_exp_f32 v154, v154
  v_exp_f32 v155, v155
  v_pk_mul_f32 v[26:27], v[26:27], v[90:91]
  v_pk_fma_f32 v[140:141], v[140:141], v[214:215], v[214:215] op_sel:[0,1,1] op_sel_hi:[1,1,1]
  v_pk_fma_f32 v[142:143], v[142:143], v[214:215], v[214:215] op_sel:[0,1,1] op_sel_hi:[1,1,1]
  v_pk_fma_f32 v[144:145], v[144:145], v[214:215], v[214:215] op_sel:[0,1,1] op_sel_hi:[1,1,1]
  v_pk_fma_f32 v[146:147], v[146:147], v[214:215], v[214:215] op_sel:[0,1,1] op_sel_hi:[1,1,1]
  v_pk_fma_f32 v[148:149], v[148:149], v[214:215], v[214:215] op_sel:[0,1,1] op_sel_hi:[1,1,1]
  v_pk_fma_f32 v[150:151], v[150:151], v[214:215], v[214:215] op_sel:[0,1,1] op_sel_hi:[1,1,1]
  v_pk_fma_f32 v[152:153], v[152:153], v[214:215], v[214:215] op_sel:[0,1,1] op_sel_hi:[1,1,1]
  v_pk_fma_f32 v[154:155], v[154:155], v[214:215], v[214:215] op_sel:[0,1,1] op_sel_hi:[1,1,1]
  v_rcp_f32 v140, v140
  v_rcp_f32 v141, v141
  v_rcp_f32 v142, v142
  v_rcp_f32 v143, v143
  v_rcp_f32 v144, v144
  v_rcp_f32 v145, v145
  v_rcp_f32 v146, v146
  v_rcp_f32 v147, v147
  v_rcp_f32 v148, v148
  v_rcp_f32 v149, v149
  v_rcp_f32 v150, v150
  v_rcp_f32 v151, v151
  v_rcp_f32 v152, v152
  v_rcp_f32 v153, v153
  v_rcp_f32 v154, v154
  v_rcp_f32 v155, v155
  v_pk_mul_f32 v[12:13], v[12:13], v[140:141]
  v_pk_mul_f32 v[14:15], v[14:15], v[142:143]
  v_pk_mul_f32 v[16:17], v[16:17], v[144:145]
  v_pk_mul_f32 v[18:19], v[18:19], v[146:147]
  v_pk_mul_f32 v[20:21], v[20:21], v[148:149]
  v_pk_mul_f32 v[22:23], v[22:23], v[150:151]
  v_pk_mul_f32 v[24:25], v[24:25], v[152:153]
  v_pk_mul_f32 v[26:27], v[26:27], v[154:155]
  v_cvt_pk_bf16_f32 v76, v12, v13
  v_cvt_pk_bf16_f32 v77, v14, v15
  ds_write_b64 v220, v[76:77] offset:0
  v_cvt_pk_bf16_f32 v78, v16, v17
  v_cvt_pk_bf16_f32 v79, v18, v19
  ds_write_b64 v220, v[78:79] offset:16
  v_cvt_pk_bf16_f32 v80, v20, v21
  v_cvt_pk_bf16_f32 v81, v22, v23
  ds_write_b64 v220, v[80:81] offset:32
  v_cvt_pk_bf16_f32 v82, v24, v25
  v_cvt_pk_bf16_f32 v83, v26, v27
  ds_write_b64 v220, v[82:83] offset:48
  v_pk_mul_f32 v[140:141], v[44:45], v[214:215] op_sel_hi:[1,0]
  v_pk_mul_f32 v[142:143], v[46:47], v[214:215] op_sel_hi:[1,0]
  v_pk_mul_f32 v[144:145], v[48:49], v[214:215] op_sel_hi:[1,0]
  v_pk_mul_f32 v[146:147], v[50:51], v[214:215] op_sel_hi:[1,0]
  v_pk_mul_f32 v[148:149], v[52:53], v[214:215] op_sel_hi:[1,0]
  v_pk_mul_f32 v[150:151], v[54:55], v[214:215] op_sel_hi:[1,0]
  v_pk_mul_f32 v[152:153], v[56:57], v[214:215] op_sel_hi:[1,0]
  v_pk_mul_f32 v[154:155], v[58:59], v[214:215] op_sel_hi:[1,0]
  v_exp_f32 v140, v140
  v_exp_f32 v141, v141
  v_pk_mul_f32 v[44:45], v[44:45], v[108:109]
  v_exp_f32 v142, v142
  v_exp_f32 v143, v143
  v_pk_mul_f32 v[46:47], v[46:47], v[110:111]
  v_exp_f32 v144, v144
  v_exp_f32 v145, v145
  v_pk_mul_f32 v[48:49], v[48:49], v[112:113]
  v_exp_f32 v146, v146
  v_exp_f32 v147, v147
  v_pk_mul_f32 v[50:51], v[50:51], v[114:115]
  v_exp_f32 v148, v148
  v_exp_f32 v149, v149
  v_pk_mul_f32 v[52:53], v[52:53], v[116:117]
  v_exp_f32 v150, v150
  v_exp_f32 v151, v151
  v_pk_mul_f32 v[54:55], v[54:55], v[118:119]
  v_exp_f32 v152, v152
  v_exp_f32 v153, v153
  v_pk_mul_f32 v[56:57], v[56:57], v[120:121]
  v_exp_f32 v154, v154
  v_exp_f32 v155, v155
  v_pk_mul_f32 v[58:59], v[58:59], v[122:123]
  v_pk_fma_f32 v[140:141], v[140:141], v[214:215], v[214:215] op_sel:[0,1,1] op_sel_hi:[1,1,1]
  v_pk_fma_f32 v[142:143], v[142:143], v[214:215], v[214:215] op_sel:[0,1,1] op_sel_hi:[1,1,1]
  v_pk_fma_f32 v[144:145], v[144:145], v[214:215], v[214:215] op_sel:[0,1,1] op_sel_hi:[1,1,1]
  v_pk_fma_f32 v[146:147], v[146:147], v[214:215], v[214:215] op_sel:[0,1,1] op_sel_hi:[1,1,1]
  v_pk_fma_f32 v[148:149], v[148:149], v[214:215], v[214:215] op_sel:[0,1,1] op_sel_hi:[1,1,1]
  v_pk_fma_f32 v[150:151], v[150:151], v[214:215], v[214:215] op_sel:[0,1,1] op_sel_hi:[1,1,1]
  v_pk_fma_f32 v[152:153], v[152:153], v[214:215], v[214:215] op_sel:[0,1,1] op_sel_hi:[1,1,1]
  v_pk_fma_f32 v[154:155], v[154:155], v[214:215], v[214:215] op_sel:[0,1,1] op_sel_hi:[1,1,1]
  v_rcp_f32 v140, v140
  v_rcp_f32 v141, v141
  v_rcp_f32 v142, v142
  v_rcp_f32 v143, v143
  v_rcp_f32 v144, v144
  v_rcp_f32 v145, v145
  v_rcp_f32 v146, v146
  v_rcp_f32 v147, v147
  v_rcp_f32 v148, v148
  v_rcp_f32 v149, v149
  v_rcp_f32 v150, v150
  v_rcp_f32 v151, v151
  v_rcp_f32 v152, v152
  v_rcp_f32 v153, v153
  v_rcp_f32 v154, v154
  v_rcp_f32 v155, v155
  v_pk_mul_f32 v[44:45], v[44:45], v[140:141]
  v_pk_mul_f32 v[46:47], v[46:47], v[142:143]
  v_pk_mul_f32 v[48:49], v[48:49], v[144:145]
  v_pk_mul_f32 v[50:51], v[50:51], v[146:147]
  v_pk_mul_f32 v[52:53], v[52:53], v[148:149]
  v_pk_mul_f32 v[54:55], v[54:55], v[150:151]
  v_pk_mul_f32 v[56:57], v[56:57], v[152:153]
  v_pk_mul_f32 v[58:59], v[58:59], v[154:155]
  v_cvt_pk_bf16_f32 v108, v44, v45
  v_cvt_pk_bf16_f32 v109, v46, v47
  ds_write_b64 v220, v[108:109] offset:64
  v_cvt_pk_bf16_f32 v110, v48, v49
  v_cvt_pk_bf16_f32 v111, v50, v51
  ds_write_b64 v220, v[110:111] offset:80
  v_cvt_pk_bf16_f32 v112, v52, v53
  v_cvt_pk_bf16_f32 v113, v54, v55
  ds_write_b64 v220, v[112:113] offset:96
  v_cvt_pk_bf16_f32 v114, v56, v57
  v_cvt_pk_bf16_f32 v115, v58, v59
  ds_write_b64 v220, v[114:115] offset:112
  s_waitcnt lgkmcnt(0)
  ds_read_b128 v[172:175], v221 offset:0
  ds_read_b128 v[176:179], v221 offset:1152
  ds_read_b128 v[180:183], v221 offset:2304
  ds_read_b128 v[184:187], v221 offset:3456
  s_waitcnt lgkmcnt(3)
  buffer_store_dwordx4 v[172:175], v222, s[44:47], s72 offen sc1
  s_add_u32 s72, s72, 1024
  s_waitcnt lgkmcnt(2)
  buffer_store_dwordx4 v[176:179], v222, s[44:47], s72 offen sc1
  s_add_u32 s72, s72, 1024
  s_waitcnt lgkmcnt(1)
  buffer_store_dwordx4 v[180:183], v222, s[44:47], s72 offen sc1
  s_add_u32 s72, s72, 1024
  s_waitcnt lgkmcnt(0)
  buffer_store_dwordx4 v[184:187], v222, s[44:47], s72 offen sc1
  s_add_u32 s72, s72, 1024
  v_pk_mul_f32 v[140:141], v[28:29], v[218:219] op_sel_hi:[1,0]
  v_pk_mul_f32 v[142:143], v[30:31], v[218:219] op_sel_hi:[1,0]
  v_pk_mul_f32 v[144:145], v[32:33], v[218:219] op_sel_hi:[1,0]
  v_pk_mul_f32 v[146:147], v[34:35], v[218:219] op_sel_hi:[1,0]
  v_pk_mul_f32 v[148:149], v[36:37], v[218:219] op_sel_hi:[1,0]
  v_pk_mul_f32 v[150:151], v[38:39], v[218:219] op_sel_hi:[1,0]
  v_pk_mul_f32 v[152:153], v[40:41], v[218:219] op_sel_hi:[1,0]
  v_pk_mul_f32 v[154:155], v[42:43], v[218:219] op_sel_hi:[1,0]
  v_exp_f32 v140, v140
  v_exp_f32 v141, v141
  v_pk_mul_f32 v[28:29], v[28:29], v[92:93]
  v_exp_f32 v142, v142
  v_exp_f32 v143, v143
  v_pk_mul_f32 v[30:31], v[30:31], v[94:95]
  v_exp_f32 v144, v144
  v_exp_f32 v145, v145
  v_pk_mul_f32 v[32:33], v[32:33], v[96:97]
  v_exp_f32 v146, v146
  v_exp_f32 v147, v147
  v_pk_mul_f32 v[34:35], v[34:35], v[98:99]
  v_exp_f32 v148, v148
  v_exp_f32 v149, v149
  v_pk_mul_f32 v[36:37], v[36:37], v[100:101]
  v_exp_f32 v150, v150
  v_exp_f32 v151, v151
  v_pk_mul_f32 v[38:39], v[38:39], v[102:103]
  v_exp_f32 v152, v152
  v_exp_f32 v153, v153
  v_pk_mul_f32 v[40:41], v[40:41], v[104:105]
  v_exp_f32 v154, v154
  v_exp_f32 v155, v155
  v_pk_mul_f32 v[42:43], v[42:43], v[106:107]
  v_pk_fma_f32 v[140:141], v[140:141], v[218:219], v[218:219] op_sel:[0,1,1] op_sel_hi:[1,1,1]
  v_pk_fma_f32 v[142:143], v[142:143], v[218:219], v[218:219] op_sel:[0,1,1] op_sel_hi:[1,1,1]
  v_pk_fma_f32 v[144:145], v[144:145], v[218:219], v[218:219] op_sel:[0,1,1] op_sel_hi:[1,1,1]
  v_pk_fma_f32 v[146:147], v[146:147], v[218:219], v[218:219] op_sel:[0,1,1] op_sel_hi:[1,1,1]
  v_pk_fma_f32 v[148:149], v[148:149], v[218:219], v[218:219] op_sel:[0,1,1] op_sel_hi:[1,1,1]
  v_pk_fma_f32 v[150:151], v[150:151], v[218:219], v[218:219] op_sel:[0,1,1] op_sel_hi:[1,1,1]
  v_pk_fma_f32 v[152:153], v[152:153], v[218:219], v[218:219] op_sel:[0,1,1] op_sel_hi:[1,1,1]
  v_pk_fma_f32 v[154:155], v[154:155], v[218:219], v[218:219] op_sel:[0,1,1] op_sel_hi:[1,1,1]
  v_rcp_f32 v140, v140
  v_rcp_f32 v141, v141
  v_rcp_f32 v142, v142
  v_rcp_f32 v143, v143
  v_rcp_f32 v144, v144
  v_rcp_f32 v145, v145
  v_rcp_f32 v146, v146
  v_rcp_f32 v147, v147
  v_rcp_f32 v148, v148
  v_rcp_f32 v149, v149
  v_rcp_f32 v150, v150
  v_rcp_f32 v151, v151
  v_rcp_f32 v152, v152
  v_rcp_f32 v153, v153
  v_rcp_f32 v154, v154
  v_rcp_f32 v155, v155
  v_pk_mul_f32 v[28:29], v[28:29], v[140:141]
  v_pk_mul_f32 v[30:31], v[30:31], v[142:143]
  v_pk_mul_f32 v[32:33], v[32:33], v[144:145]
  v_pk_mul_f32 v[34:35], v[34:35], v[146:147]
  v_pk_mul_f32 v[36:37], v[36:37], v[148:149]
  v_pk_mul_f32 v[38:39], v[38:39], v[150:151]
  v_pk_mul_f32 v[40:41], v[40:41], v[152:153]
  v_pk_mul_f32 v[42:43], v[42:43], v[154:155]
  v_cvt_pk_bf16_f32 v92, v28, v29
  v_cvt_pk_bf16_f32 v93, v30, v31
  ds_write_b64 v220, v[92:93] offset:4608
  v_cvt_pk_bf16_f32 v94, v32, v33
  v_cvt_pk_bf16_f32 v95, v34, v35
  ds_write_b64 v220, v[94:95] offset:4624
  v_cvt_pk_bf16_f32 v96, v36, v37
  v_cvt_pk_bf16_f32 v97, v38, v39
  ds_write_b64 v220, v[96:97] offset:4640
  v_cvt_pk_bf16_f32 v98, v40, v41
  v_cvt_pk_bf16_f32 v99, v42, v43
  ds_write_b64 v220, v[98:99] offset:4656
  v_pk_mul_f32 v[140:141], v[60:61], v[218:219] op_sel_hi:[1,0]
  v_pk_mul_f32 v[142:143], v[62:63], v[218:219] op_sel_hi:[1,0]
  v_pk_mul_f32 v[144:145], v[64:65], v[218:219] op_sel_hi:[1,0]
  v_pk_mul_f32 v[146:147], v[66:67], v[218:219] op_sel_hi:[1,0]
  v_pk_mul_f32 v[148:149], v[68:69], v[218:219] op_sel_hi:[1,0]
  v_pk_mul_f32 v[150:151], v[70:71], v[218:219] op_sel_hi:[1,0]
  v_pk_mul_f32 v[152:153], v[72:73], v[218:219] op_sel_hi:[1,0]
  v_pk_mul_f32 v[154:155], v[74:75], v[218:219] op_sel_hi:[1,0]
  v_exp_f32 v140, v140
  v_exp_f32 v141, v141
  v_pk_mul_f32 v[60:61], v[60:61], v[124:125]
  v_exp_f32 v142, v142
  v_exp_f32 v143, v143
  v_pk_mul_f32 v[62:63], v[62:63], v[126:127]
  v_exp_f32 v144, v144
  v_exp_f32 v145, v145
  v_pk_mul_f32 v[64:65], v[64:65], v[128:129]
  v_exp_f32 v146, v146
  v_exp_f32 v147, v147
  v_pk_mul_f32 v[66:67], v[66:67], v[130:131]
  v_exp_f32 v148, v148
  v_exp_f32 v149, v149
  v_pk_mul_f32 v[68:69], v[68:69], v[132:133]
  v_exp_f32 v150, v150
  v_exp_f32 v151, v151
  v_pk_mul_f32 v[70:71], v[70:71], v[134:135]
  v_exp_f32 v152, v152
  v_exp_f32 v153, v153
  v_pk_mul_f32 v[72:73], v[72:73], v[136:137]
  v_exp_f32 v154, v154
  v_exp_f32 v155, v155
  v_pk_mul_f32 v[74:75], v[74:75], v[138:139]
  v_pk_fma_f32 v[140:141], v[140:141], v[218:219], v[218:219] op_sel:[0,1,1] op_sel_hi:[1,1,1]
  v_pk_fma_f32 v[142:143], v[142:143], v[218:219], v[218:219] op_sel:[0,1,1] op_sel_hi:[1,1,1]
  v_pk_fma_f32 v[144:145], v[144:145], v[218:219], v[218:219] op_sel:[0,1,1] op_sel_hi:[1,1,1]
  v_pk_fma_f32 v[146:147], v[146:147], v[218:219], v[218:219] op_sel:[0,1,1] op_sel_hi:[1,1,1]
  v_pk_fma_f32 v[148:149], v[148:149], v[218:219], v[218:219] op_sel:[0,1,1] op_sel_hi:[1,1,1]
  v_pk_fma_f32 v[150:151], v[150:151], v[218:219], v[218:219] op_sel:[0,1,1] op_sel_hi:[1,1,1]
  v_pk_fma_f32 v[152:153], v[152:153], v[218:219], v[218:219] op_sel:[0,1,1] op_sel_hi:[1,1,1]
  v_pk_fma_f32 v[154:155], v[154:155], v[218:219], v[218:219] op_sel:[0,1,1] op_sel_hi:[1,1,1]
  v_rcp_f32 v140, v140
  v_rcp_f32 v141, v141
  v_rcp_f32 v142, v142
  v_rcp_f32 v143, v143
  v_rcp_f32 v144, v144
  v_rcp_f32 v145, v145
  v_rcp_f32 v146, v146
  v_rcp_f32 v147, v147
  v_rcp_f32 v148, v148
  v_rcp_f32 v149, v149
  v_rcp_f32 v150, v150
  v_rcp_f32 v151, v151
  v_rcp_f32 v152, v152
  v_rcp_f32 v153, v153
  v_rcp_f32 v154, v154
  v_rcp_f32 v155, v155
  v_pk_mul_f32 v[60:61], v[60:61], v[140:141]
  v_pk_mul_f32 v[62:63], v[62:63], v[142:143]
  v_pk_mul_f32 v[64:65], v[64:65], v[144:145]
  v_pk_mul_f32 v[66:67], v[66:67], v[146:147]
  v_pk_mul_f32 v[68:69], v[68:69], v[148:149]
  v_pk_mul_f32 v[70:71], v[70:71], v[150:151]
  v_pk_mul_f32 v[72:73], v[72:73], v[152:153]
  v_pk_mul_f32 v[74:75], v[74:75], v[154:155]
  v_cvt_pk_bf16_f32 v124, v60, v61
  v_cvt_pk_bf16_f32 v125, v62, v63
  ds_write_b64 v220, v[124:125] offset:4672
  v_cvt_pk_bf16_f32 v126, v64, v65
  v_cvt_pk_bf16_f32 v127, v66, v67
  ds_write_b64 v220, v[126:127] offset:4688
  v_cvt_pk_bf16_f32 v128, v68, v69
  v_cvt_pk_bf16_f32 v129, v70, v71
  ds_write_b64 v220, v[128:129] offset:4704
  v_cvt_pk_bf16_f32 v130, v72, v73
  v_cvt_pk_bf16_f32 v131, v74, v75
  ds_write_b64 v220, v[130:131] offset:4720
  s_waitcnt lgkmcnt(0)
  ds_read_b128 v[172:175], v221 offset:4608
  ds_read_b128 v[176:179], v221 offset:5760
  ds_read_b128 v[180:183], v221 offset:6912
  ds_read_b128 v[184:187], v221 offset:8064
  s_waitcnt lgkmcnt(3)
  buffer_store_dwordx4 v[172:175], v222, s[44:47], s72 offen sc1
  s_add_u32 s72, s72, 1024
  s_waitcnt lgkmcnt(2)
  buffer_store_dwordx4 v[176:179], v222, s[44:47], s72 offen sc1
  s_add_u32 s72, s72, 1024
  s_waitcnt lgkmcnt(1)
  buffer_store_dwordx4 v[180:183], v222, s[44:47], s72 offen sc1
  s_add_u32 s72, s72, 1024
  s_waitcnt lgkmcnt(0)
  buffer_store_dwordx4 v[184:187], v222, s[44:47], s72 offen sc1
  s_add_u32 s72, s72, 1024
  s_waitcnt vmcnt(0)
  s_barrier
  s_barrier
  s_branch s4_start
s3_idle:
  s_mov_b32 s48, s28
  s_mov_b32 s49, s29
  s_mov_b32 s50, 1835008
  s_mov_b32 s51, 0x20000
  s_lshr_b32 s61, s59, 4
  s_lshl_b32 s61, s61, 1
  s_add_u32 s61, s61, s58
  s_sub_u32 s61, s61, 14
  s_lshl_b32 s61, s61, 2
  s_add_u32 s61, s61, s52
  s_lshl_b32 s61, s61, 13
  s_add_u32 s62, s61, 1835008
  s_add_u32 s61, s61, 786432
  s_lshl_b32 s62, s61, 3
  s_sub_u32 s62, s62, 6291072
  v_lshlrev_b32 v3, 10, v0
  s_cmp_ge_u32 s62, 786432
  s_cbranch_scc1 s3_pf2
  buffer_load_dword v7, v3, s[48:51], s62 offen
s3_pf2:
  buffer_load_dword v7, v6, s[48:51], s61 offen
  s_waitcnt vmcnt(3)
  s_add_u32 s61, s61, 131072
  s_cmp_lt_u32 s61, 1835008
  s_cbranch_scc1 s3_pf2
  s_barrier
s4_start:
  v_bfe_u32 v3, v0, 3, 1
  v_xor_b32 v3, s66, v3
  v_lshlrev_b32 v3, 6, v3
  v_bfe_u32 v4, v0, 4, 1
  v_lshl_add_u32 v3, v4, 5, v3
  v_and_b32 v4, 3, v0
  v_lshl_add_u32 v3, v4, 3, v3
  v_bfe_u32 v4, v0, 2, 2
  v_lshl_add_u32 v3, v4, 7, v3
  v_lshl_add_u32 v242, v2, 10, v3
  s_lshl_b32 s61, s65, 12
  s_add_u32 s61, s61, 65536
  v_add_u32 v242, s61, v242
  v_add_u32 v243, 49152, v242
  ds_read_b64_tr_b16 v[92:93], v243 offset:16384
  ds_read_b64_tr_b16 v[94:95], v243 offset:16896
  ds_read_b64_tr_b16 v[96:97], v243 offset:18432
  ds_read_b64_tr_b16 v[98:99], v243 offset:18944
  ds_read_b64_tr_b16 v[100:101], v243 offset:24576
  ds_read_b64_tr_b16 v[102:103], v243 offset:25088
  ds_read_b64_tr_b16 v[104:105], v243 offset:26624
  ds_read_b64_tr_b16 v[106:107], v243 offset:27136
  s_waitcnt lgkmcnt(4)
  ds_read_b64_tr_b16 v[108:109], v243 offset:32768
  ds_read_b64_tr_b16 v[110:111], v243 offset:33280
  ds_read_b64_tr_b16 v[112:113], v243 offset:34816
  ds_read_b64_tr_b16 v[114:115], v243 offset:35328
  ds_read_b64_tr_b16 v[116:117], v243 offset:40960
  ds_read_b64_tr_b16 v[118:119], v243 offset:41472
  ds_read_b64_tr_b16 v[120:121], v243 offset:43008
  ds_read_b64_tr_b16 v[122:123], v243 offset:43520
  s_waitcnt lgkmcnt(4)
  ds_read_b64_tr_b16 v[124:125], v242 offset:0
  ds_read_b64_tr_b16 v[126:127], v242 offset:512
  ds_read_b64_tr_b16 v[128:129], v242 offset:2048
  ds_read_b64_tr_b16 v[130:131], v242 offset:2560
  ds_read_b64_tr_b16 v[132:133], v242 offset:8192
  ds_read_b64_tr_b16 v[134:135], v242 offset:8704
  ds_read_b64_tr_b16 v[136:137], v242 offset:10240
  ds_read_b64_tr_b16 v[138:139], v242 offset:10752
  s_waitcnt lgkmcnt(4)
  ds_read_b64_tr_b16 v[140:141], v242 offset:16384
  ds_read_b64_tr_b16 v[142:143], v242 offset:16896
  ds_read_b64_tr_b16 v[144:145], v242 offset:18432
  ds_read_b64_tr_b16 v[146:147], v242 offset:18944
  ds_read_b64_tr_b16 v[148:149], v242 offset:24576
  ds_read_b64_tr_b16 v[150:151], v242 offset:25088
  ds_read_b64_tr_b16 v[152:153], v242 offset:26624
  ds_read_b64_tr_b16 v[154:155], v242 offset:27136
  s_waitcnt lgkmcnt(4)
  ds_read_b64_tr_b16 v[156:157], v242 offset:32768
  ds_read_b64_tr_b16 v[158:159], v242 offset:33280
  ds_read_b64_tr_b16 v[160:161], v242 offset:34816
  ds_read_b64_tr_b16 v[162:163], v242 offset:35328
  ds_read_b64_tr_b16 v[164:165], v242 offset:40960
  ds_read_b64_tr_b16 v[166:167], v242 offset:41472
  ds_read_b64_tr_b16 v[168:169], v242 offset:43008
  ds_read_b64_tr_b16 v[170:171], v242 offset:43520
  s_waitcnt lgkmcnt(4)
  ds_read_b64_tr_b16 v[172:173], v243 offset:0
  ds_read_b64_tr_b16 v[174:175], v243 offset:512
  ds_read_b64_tr_b16 v[176:177], v243 offset:2048
  ds_read_b64_tr_b16 v[178:179], v243 offset:2560
  ds_read_b64_tr_b16 v[180:181], v243 offset:8192
  ds_read_b64_tr_b16 v[182:183], v243 offset:8704
  ds_read_b64_tr_b16 v[184:185], v243 offset:10240
  ds_read_b64_tr_b16 v[186:187], v243 offset:10752
  s_waitcnt lgkmcnt(4)
  s_waitcnt lgkmcnt(0)
  s_barrier
  s_mov_b32 s48, s30
  s_mov_b32 s49, s31
  s_mov_b32 s50, 2097152
  s_mov_b32 s51, 0x20000
  v_bfe_u32 v3, v1, 1, 3
  v_xor_b32 v3, v3, v2
  v_lshlrev_b32 v3, 4, v3
  v_lshl_add_u32 v3, v1, 7, v3
  s_lshl_b32 s61, s65, 6
  v_xor_b32 v236, s61, v3
  v_xor_b32 v237, 32, v236
  v_add_u32 v238, 65536, v236
  v_add_u32 v239, 65536, v237
  v_add_u32 v240, 131072, v236
  v_add_u32 v241, 131072, v237
  s_lshl_b32 s61, s65, 5
  v_add_u32 v3, s61, v1
  v_mul_u32_u24 v245, 144, v3
  v_lshl_add_u32 v245, v2, 3, v245
  s_lshl_b32 s61, s66, 6
  v_add_u32 v245, s61, v245
  v_lshrrev_b32 v3, 3, v0
  s_lshl_b32 s61, s52, 4
  v_add_u32 v3, s61, v3
  v_and_b32 v4, 7, v0
  v_lshlrev_b32 v4, 4, v4
  v_lshl_add_u32 v244, v3, 10, v4
  v_mul_u32_u24 v246, 144, v3
  v_add_u32 v246, v246, v4
  s_lshl_b32 s61, s52, 12
  s_add_u32 s61, s61, 32768
  v_lshl_add_u32 v247, v0, 4, s61
  v_mov_b32 v12, 0
  v_mov_b32 v13, 0
  v_mov_b32 v14, 0
  v_mov_b32 v15, 0
  v_mov_b32 v16, 0
  v_mov_b32 v17, 0
  v_mov_b32 v18, 0
  v_mov_b32 v19, 0
  v_mov_b32 v20, 0
  v_mov_b32 v21, 0
  v_mov_b32 v22, 0
  v_mov_b32 v23, 0
  v_mov_b32 v24, 0
  v_mov_b32 v25, 0
  v_mov_b32 v26, 0
  v_mov_b32 v27, 0
  v_mov_b32 v28, 0
  v_mov_b32 v29, 0
  v_mov_b32 v30, 0
  v_mov_b32 v31, 0
  v_mov_b32 v32, 0
  v_mov_b32 v33, 0
  v_mov_b32 v34, 0
  v_mov_b32 v35, 0
  v_mov_b32 v36, 0
  v_mov_b32 v37, 0
  v_mov_b32 v38, 0
  v_mov_b32 v39, 0
  v_mov_b32 v40, 0
  v_mov_b32 v41, 0
  v_mov_b32 v42, 0
  v_mov_b32 v43, 0
  s_mov_b64 vcc, 0
  s_cmp_lg_u32 s52, 0
  s_cbranch_scc1 p3_a
  s_lshl_b32 s61, s57, 12
  s_add_u32 s61, s61, 15007744
  s_xor_b32 s61, s61, 0
  v_min_u32 v3, 13, v0
  v_lshlrev_b32 v3, 7, v3
  s_mov_b32 s64, 1
poll_10:
  buffer_load_dwordx2 v[8:9], v3, s[44:47], s61 offen sc1
  s_waitcnt vmcnt(0)
  v_cmp_ne_u64 vcc, s[22:23], v[8:9]
  s_nop 1
  s_cmp_eq_u64 vcc, 0
  s_cbranch_scc1 polld_11
  s_sleep 0
  s_sub_u32 s64, s64, 1
  s_cbranch_scc0 poll_10
polld_11:
p3_a:
  s_barrier
  ds_read_b64_tr_b16 v[188:189], v243 offset:16384
  ds_read_b64_tr_b16 v[190:191], v243 offset:16896
  ds_read_b64_tr_b16 v[192:193], v243 offset:18432
  ds_read_b64_tr_b16 v[194:195], v243 offset:18944
  ds_read_b64_tr_b16 v[196:197], v243 offset:24576
  ds_read_b64_tr_b16 v[198:199], v243 offset:25088
  ds_read_b64_tr_b16 v[200:201], v243 offset:26624
  ds_read_b64_tr_b16 v[202:203], v243 offset:27136
  s_waitcnt lgkmcnt(4)
  ds_read_b64_tr_b16 v[204:205], v243 offset:32768
  ds_read_b64_tr_b16 v[206:207], v243 offset:33280
  ds_read_b64_tr_b16 v[208:209], v243 offset:34816
  ds_read_b64_tr_b16 v[210:211], v243 offset:35328
  ds_read_b64_tr_b16 v[212:213], v243 offset:40960
  ds_read_b64_tr_b16 v[214:215], v243 offset:41472
  ds_read_b64_tr_b16 v[216:217], v243 offset:43008
  ds_read_b64_tr_b16 v[218:219], v243 offset:43520
  s_waitcnt lgkmcnt(4)
  ds_read_b64_tr_b16 v[220:221], v242 offset:0
  ds_read_b64_tr_b16 v[222:223], v242 offset:512
  ds_read_b64_tr_b16 v[224:225], v242 offset:2048
  ds_read_b64_tr_b16 v[226:227], v242 offset:2560
  ds_read_b64_tr_b16 v[228:229], v242 offset:8192
  ds_read_b64_tr_b16 v[230:231], v242 offset:8704
  ds_read_b64_tr_b16 v[232:233], v242 offset:10240
  ds_read_b64_tr_b16 v[234:235], v242 offset:10752
  s_waitcnt lgkmcnt(4)
  s_waitcnt lgkmcnt(0)
  s_cmp_eq_u64 vcc, 0
  s_cbranch_scc1 p3_done
  v_min_u32 v3, 13, v0
  v_lshlrev_b32 v3, 7, v3
  s_mov_b32 s64, 32768
  s_mov_b64 s[62:63], -1
poll_12:
  buffer_load_dwordx2 v[8:9], v3, s[44:47], s61 offen sc1
  s_waitcnt vmcnt(0)
  v_cmp_ne_u64 vcc, s[22:23], v[8:9]
  s_nop 1
  s_and_b64 s[62:63], s[62:63], vcc
  s_cbranch_scc0 polld_13
  s_sub_u32 s64, s64, 1
  s_cbranch_scc1 polld_13
  s_cmp_gt_u32 s64, 32744
  s_cbranch_scc1 poll_12
  buffer_load_dwordx2 v[8:9], v3, s[44:47], s61 offen offset:2048 sc1
  s_waitcnt vmcnt(0)
  v_cmp_ne_u64 vcc, s[22:23], v[8:9]
  s_nop 1
  s_and_b64 s[62:63], s[62:63], vcc
  s_cbranch_scc0 polld_13
  s_branch poll_12
polld_13:
p3_done:
  s_barrier
  s_barrier
  ds_read_b128 v[44:47], v236 offset:0
  ds_read_b128 v[48:51], v236 offset:4096
  ds_read_b128 v[52:55], v237 offset:0
  ds_read_b128 v[56:59], v237 offset:4096
  ds_read_b128 v[60:63], v236 offset:8192
  ds_read_b128 v[64:67], v236 offset:12288
  ds_read_b128 v[68:71], v237 offset:8192
  ds_read_b128 v[72:75], v237 offset:12288
  s_waitcnt lgkmcnt(6)
  v_mfma_f32_32x32x16_bf16 v[12:27], v[92:95], v[44:47], v[12:27]
  v_mfma_f32_32x32x16_bf16 v[28:43], v[92:95], v[48:51], v[28:43]
  s_waitcnt lgkmcnt(4)
  v_mfma_f32_32x32x16_bf16 v[12:27], v[96:99], v[52:55], v[12:27]
  v_mfma_f32_32x32x16_bf16 v[28:43], v[96:99], v[56:59], v[28:43]
  s_waitcnt lgkmcnt(0)
  s_barrier
  v_mfma_f32_32x32x16_bf16 v[12:27], v[100:103], v[60:63], v[12:27]
  ds_read_b128 v[44:47], v236 offset:16384
  ds_read_b128 v[48:51], v236 offset:20480
  v_mfma_f32_32x32x16_bf16 v[28:43], v[100:103], v[64:67], v[28:43]
  ds_read_b128 v[52:55], v237 offset:16384
  ds_read_b128 v[56:59], v237 offset:20480
  v_mfma_f32_32x32x16_bf16 v[12:27], v[104:107], v[68:71], v[12:27]
  v_mfma_f32_32x32x16_bf16 v[28:43], v[104:107], v[72:75], v[28:43]
  ds_read_b128 v[60:63], v236 offset:24576
  ds_read_b128 v[64:67], v236 offset:28672
  ds_read_b128 v[68:71], v237 offset:24576
  ds_read_b128 v[72:75], v237 offset:28672
  s_waitcnt lgkmcnt(6)
  v_mfma_f32_32x32x16_bf16 v[12:27], v[108:111], v[44:47], v[12:27]
  v_mfma_f32_32x32x16_bf16 v[28:43], v[108:111], v[48:51], v[28:43]
  s_waitcnt lgkmcnt(4)
  v_mfma_f32_32x32x16_bf16 v[12:27], v[112:115], v[52:55], v[12:27]
  v_mfma_f32_32x32x16_bf16 v[28:43], v[112:115], v[56:59], v[28:43]
  s_waitcnt lgkmcnt(0)
  s_barrier
  v_mfma_f32_32x32x16_bf16 v[12:27], v[116:119], v[60:63], v[12:27]
  ds_read_b128 v[44:47], v236 offset:32768
  ds_read_b128 v[48:51], v236 offset:36864
  v_mfma_f32_32x32x16_bf16 v[28:43], v[116:119], v[64:67], v[28:43]
  ds_read_b128 v[52:55], v237 offset:32768
  ds_read_b128 v[56:59], v237 offset:36864
  v_mfma_f32_32x32x16_bf16 v[12:27], v[120:123], v[68:71], v[12:27]
  v_mfma_f32_32x32x16_bf16 v[28:43], v[120:123], v[72:75], v[28:43]
  ds_read_b128 v[60:63], v236 offset:40960
  ds_read_b128 v[64:67], v236 offset:45056
  ds_read_b128 v[68:71], v237 offset:40960
  ds_read_b128 v[72:75], v237 offset:45056
  s_waitcnt lgkmcnt(6)
  v_mfma_f32_32x32x16_bf16 v[12:27], v[124:127], v[44:47], v[12:27]
  v_mfma_f32_32x32x16_bf16 v[28:43], v[124:127], v[48:51], v[28:43]
  s_waitcnt lgkmcnt(4)
  v_mfma_f32_32x32x16_bf16 v[12:27], v[128:131], v[52:55], v[12:27]
  v_mfma_f32_32x32x16_bf16 v[28:43], v[128:131], v[56:59], v[28:43]
  s_waitcnt lgkmcnt(0)
  s_barrier
  v_mfma_f32_32x32x16_bf16 v[12:27], v[132:135], v[60:63], v[12:27]
  ds_read_b128 v[44:47], v236 offset:49152
  ds_read_b128 v[48:51], v236 offset:53248
  v_mfma_f32_32x32x16_bf16 v[28:43], v[132:135], v[64:67], v[28:43]
  ds_read_b128 v[52:55], v237 offset:49152
  ds_read_b128 v[56:59], v237 offset:53248
  v_mfma_f32_32x32x16_bf16 v[12:27], v[136:139], v[68:71], v[12:27]
  v_mfma_f32_32x32x16_bf16 v[28:43], v[136:139], v[72:75], v[28:43]
  ds_read_b128 v[60:63], v236 offset:57344
  ds_read_b128 v[64:67], v236 offset:61440
  ds_read_b128 v[68:71], v237 offset:57344
  ds_read_b128 v[72:75], v237 offset:61440
  s_waitcnt lgkmcnt(6)
  v_mfma_f32_32x32x16_bf16 v[12:27], v[140:143], v[44:47], v[12:27]
  v_mfma_f32_32x32x16_bf16 v[28:43], v[140:143], v[48:51], v[28:43]
  s_waitcnt lgkmcnt(4)
  v_mfma_f32_32x32x16_bf16 v[12:27], v[144:147], v[52:55], v[12:27]
  v_mfma_f32_32x32x16_bf16 v[28:43], v[144:147], v[56:59], v[28:43]
  s_waitcnt lgkmcnt(0)
  s_barrier
  v_mfma_f32_32x32x16_bf16 v[12:27], v[148:151], v[60:63], v[12:27]
  ds_read_b128 v[44:47], v238 offset:0
  ds_read_b128 v[48:51], v238 offset:4096
  v_mfma_f32_32x32x16_bf16 v[28:43], v[148:151], v[64:67], v[28:43]
  ds_read_b128 v[52:55], v239 offset:0
  ds_read_b128 v[56:59], v239 offset:4096
  v_mfma_f32_32x32x16_bf16 v[12:27], v[152:155], v[68:71], v[12:27]
  v_mfma_f32_32x32x16_bf16 v[28:43], v[152:155], v[72:75], v[28:43]
  ds_read_b128 v[60:63], v238 offset:8192
  ds_read_b128 v[64:67], v238 offset:12288
  ds_read_b128 v[68:71], v239 offset:8192
  ds_read_b128 v[72:75], v239 offset:12288
  s_waitcnt lgkmcnt(6)
  v_mfma_f32_32x32x16_bf16 v[12:27], v[156:159], v[44:47], v[12:27]
  v_mfma_f32_32x32x16_bf16 v[28:43], v[156:159], v[48:51], v[28:43]
  s_waitcnt lgkmcnt(4)
  v_mfma_f32_32x32x16_bf16 v[12:27], v[160:163], v[52:55], v[12:27]
  v_mfma_f32_32x32x16_bf16 v[28:43], v[160:163], v[56:59], v[28:43]
  s_waitcnt lgkmcnt(0)
  s_barrier
  v_mfma_f32_32x32x16_bf16 v[12:27], v[164:167], v[60:63], v[12:27]
  ds_read_b128 v[44:47], v240 offset:0
  ds_read_b128 v[48:51], v240 offset:4096
  v_mfma_f32_32x32x16_bf16 v[28:43], v[164:167], v[64:67], v[28:43]
  ds_read_b128 v[52:55], v241 offset:0
  ds_read_b128 v[56:59], v241 offset:4096
  v_mfma_f32_32x32x16_bf16 v[12:27], v[168:171], v[68:71], v[12:27]
  v_mfma_f32_32x32x16_bf16 v[28:43], v[168:171], v[72:75], v[28:43]
  ds_read_b128 v[60:63], v240 offset:8192
  ds_read_b128 v[64:67], v240 offset:12288
  ds_read_b128 v[68:71], v241 offset:8192
  ds_read_b128 v[72:75], v241 offset:12288
  s_waitcnt lgkmcnt(6)
  v_mfma_f32_32x32x16_bf16 v[12:27], v[172:175], v[44:47], v[12:27]
  v_mfma_f32_32x32x16_bf16 v[28:43], v[172:175], v[48:51], v[28:43]
  s_waitcnt lgkmcnt(4)
  v_mfma_f32_32x32x16_bf16 v[12:27], v[176:179], v[52:55], v[12:27]
  v_mfma_f32_32x32x16_bf16 v[28:43], v[176:179], v[56:59], v[28:43]
  s_waitcnt lgkmcnt(0)
  s_barrier
  v_mfma_f32_32x32x16_bf16 v[12:27], v[180:183], v[60:63], v[12:27]
  ds_read_b128 v[44:47], v240 offset:16384
  ds_read_b128 v[48:51], v240 offset:20480
  v_mfma_f32_32x32x16_bf16 v[28:43], v[180:183], v[64:67], v[28:43]
  ds_read_b128 v[52:55], v241 offset:16384
  ds_read_b128 v[56:59], v241 offset:20480
  v_mfma_f32_32x32x16_bf16 v[12:27], v[184:187], v[68:71], v[12:27]
  v_mfma_f32_32x32x16_bf16 v[28:43], v[184:187], v[72:75], v[28:43]
  ds_read_b128 v[60:63], v240 offset:24576
  ds_read_b128 v[64:67], v240 offset:28672
  ds_read_b128 v[68:71], v241 offset:24576
  ds_read_b128 v[72:75], v241 offset:28672
  s_waitcnt lgkmcnt(6)
  v_mfma_f32_32x32x16_bf16 v[12:27], v[188:191], v[44:47], v[12:27]
  v_mfma_f32_32x32x16_bf16 v[28:43], v[188:191], v[48:51], v[28:43]
  s_waitcnt lgkmcnt(4)
  v_mfma_f32_32x32x16_bf16 v[12:27], v[192:195], v[52:55], v[12:27]
  v_mfma_f32_32x32x16_bf16 v[28:43], v[192:195], v[56:59], v[28:43]
  s_waitcnt lgkmcnt(0)
  s_barrier
  v_mfma_f32_32x32x16_bf16 v[12:27], v[196:199], v[60:63], v[12:27]
  ds_read_b128 v[44:47], v236 offset:0
  ds_read_b128 v[48:51], v236 offset:4096
  v_mfma_f32_32x32x16_bf16 v[28:43], v[196:199], v[64:67], v[28:43]
  ds_read_b128 v[52:55], v237 offset:0
  ds_read_b128 v[56:59], v237 offset:4096
  v_mfma_f32_32x32x16_bf16 v[12:27], v[200:203], v[68:71], v[12:27]
  v_mfma_f32_32x32x16_bf16 v[28:43], v[200:203], v[72:75], v[28:43]
  ds_read_b128 v[60:63], v236 offset:8192
  ds_read_b128 v[64:67], v236 offset:12288
  ds_read_b128 v[68:71], v237 offset:8192
  ds_read_b128 v[72:75], v237 offset:12288
  s_waitcnt lgkmcnt(6)
  v_mfma_f32_32x32x16_bf16 v[12:27], v[204:207], v[44:47], v[12:27]
  v_mfma_f32_32x32x16_bf16 v[28:43], v[204:207], v[48:51], v[28:43]
  s_waitcnt lgkmcnt(4)
  v_mfma_f32_32x32x16_bf16 v[12:27], v[208:211], v[52:55], v[12:27]
  v_mfma_f32_32x32x16_bf16 v[28:43], v[208:211], v[56:59], v[28:43]
  s_waitcnt lgkmcnt(0)
  s_barrier
  v_mfma_f32_32x32x16_bf16 v[12:27], v[212:215], v[60:63], v[12:27]
  ds_read_b128 v[44:47], v236 offset:16384
  ds_read_b128 v[48:51], v236 offset:20480
  v_mfma_f32_32x32x16_bf16 v[28:43], v[212:215], v[64:67], v[28:43]
  ds_read_b128 v[52:55], v237 offset:16384
  ds_read_b128 v[56:59], v237 offset:20480
  v_mfma_f32_32x32x16_bf16 v[12:27], v[216:219], v[68:71], v[12:27]
  v_mfma_f32_32x32x16_bf16 v[28:43], v[216:219], v[72:75], v[28:43]
  ds_read_b128 v[60:63], v236 offset:24576
  ds_read_b128 v[64:67], v236 offset:28672
  ds_read_b128 v[68:71], v237 offset:24576
  ds_read_b128 v[72:75], v237 offset:28672
  s_waitcnt lgkmcnt(6)
  v_mfma_f32_32x32x16_bf16 v[12:27], v[220:223], v[44:47], v[12:27]
  v_mfma_f32_32x32x16_bf16 v[28:43], v[220:223], v[48:51], v[28:43]
  s_waitcnt lgkmcnt(4)
  v_mfma_f32_32x32x16_bf16 v[12:27], v[224:227], v[52:55], v[12:27]
  v_mfma_f32_32x32x16_bf16 v[28:43], v[224:227], v[56:59], v[28:43]
  s_waitcnt lgkmcnt(0)
  s_barrier
  v_mfma_f32_32x32x16_bf16 v[12:27], v[228:231], v[60:63], v[12:27]
  ds_read_b64_tr_b16 v[76:77], v242 offset:16384
  ds_read_b64_tr_b16 v[78:79], v242 offset:16896
  ds_read_b128 v[44:47], v236 offset:32768
  ds_read_b128 v[48:51], v236 offset:36864
  v_mfma_f32_32x32x16_bf16 v[28:43], v[228:231], v[64:67], v[28:43]
  ds_read_b64_tr_b16 v[80:81], v242 offset:18432
  ds_read_b64_tr_b16 v[82:83], v242 offset:18944
  ds_read_b128 v[52:55], v237 offset:32768
  ds_read_b128 v[56:59], v237 offset:36864
  v_mfma_f32_32x32x16_bf16 v[12:27], v[232:235], v[68:71], v[12:27]
  v_mfma_f32_32x32x16_bf16 v[28:43], v[232:235], v[72:75], v[28:43]
  ds_read_b64_tr_b16 v[84:85], v242 offset:24576
  ds_read_b64_tr_b16 v[86:87], v242 offset:25088
  ds_read_b128 v[60:63], v236 offset:40960
  ds_read_b128 v[64:67], v236 offset:45056
  ds_read_b64_tr_b16 v[88:89], v242 offset:26624
  ds_read_b64_tr_b16 v[90:91], v242 offset:27136
  ds_read_b128 v[68:71], v237 offset:40960
  ds_read_b128 v[72:75], v237 offset:45056
  s_waitcnt lgkmcnt(12)
  v_mfma_f32_32x32x16_bf16 v[12:27], v[76:79], v[44:47], v[12:27]
  v_mfma_f32_32x32x16_bf16 v[28:43], v[76:79], v[48:51], v[28:43]
  s_waitcnt lgkmcnt(8)
  v_mfma_f32_32x32x16_bf16 v[12:27], v[80:83], v[52:55], v[12:27]
  v_mfma_f32_32x32x16_bf16 v[28:43], v[80:83], v[56:59], v[28:43]
  s_waitcnt lgkmcnt(0)
  s_barrier
  v_mfma_f32_32x32x16_bf16 v[12:27], v[84:87], v[60:63], v[12:27]
  ds_read_b64_tr_b16 v[76:77], v242 offset:32768
  ds_read_b64_tr_b16 v[78:79], v242 offset:33280
  ds_read_b128 v[44:47], v236 offset:49152
  ds_read_b128 v[48:51], v236 offset:53248
  v_mfma_f32_32x32x16_bf16 v[28:43], v[84:87], v[64:67], v[28:43]
  ds_read_b64_tr_b16 v[80:81], v242 offset:34816
  ds_read_b64_tr_b16 v[82:83], v242 offset:35328
  ds_read_b128 v[52:55], v237 offset:49152
  ds_read_b128 v[56:59], v237 offset:53248
  v_mfma_f32_32x32x16_bf16 v[12:27], v[88:91], v[68:71], v[12:27]
  v_mfma_f32_32x32x16_bf16 v[28:43], v[88:91], v[72:75], v[28:43]
  ds_read_b64_tr_b16 v[84:85], v242 offset:40960
  ds_read_b64_tr_b16 v[86:87], v242 offset:41472
  ds_read_b128 v[60:63], v236 offset:57344
  ds_read_b128 v[64:67], v236 offset:61440
  ds_read_b64_tr_b16 v[88:89], v242 offset:43008
  ds_read_b64_tr_b16 v[90:91], v242 offset:43520
  ds_read_b128 v[68:71], v237 offset:57344
  ds_read_b128 v[72:75], v237 offset:61440
  s_waitcnt lgkmcnt(12)
  v_mfma_f32_32x32x16_bf16 v[12:27], v[76:79], v[44:47], v[12:27]
  v_mfma_f32_32x32x16_bf16 v[28:43], v[76:79], v[48:51], v[28:43]
  s_waitcnt lgkmcnt(8)
  v_mfma_f32_32x32x16_bf16 v[12:27], v[80:83], v[52:55], v[12:27]
  v_mfma_f32_32x32x16_bf16 v[28:43], v[80:83], v[56:59], v[28:43]
  s_waitcnt lgkmcnt(0)
  s_barrier
  v_mfma_f32_32x32x16_bf16 v[12:27], v[84:87], v[60:63], v[12:27]
  ds_read_b64_tr_b16 v[76:77], v243 offset:0
  ds_read_b64_tr_b16 v[78:79], v243 offset:512
  ds_read_b128 v[44:47], v238 offset:0
  ds_read_b128 v[48:51], v238 offset:4096
  v_mfma_f32_32x32x16_bf16 v[28:43], v[84:87], v[64:67], v[28:43]
  ds_read_b64_tr_b16 v[80:81], v243 offset:2048
  ds_read_b64_tr_b16 v[82:83], v243 offset:2560
  ds_read_b128 v[52:55], v239 offset:0
  ds_read_b128 v[56:59], v239 offset:4096
  v_mfma_f32_32x32x16_bf16 v[12:27], v[88:91], v[68:71], v[12:27]
  v_mfma_f32_32x32x16_bf16 v[28:43], v[88:91], v[72:75], v[28:43]
  ds_read_b64_tr_b16 v[84:85], v243 offset:8192
  ds_read_b64_tr_b16 v[86:87], v243 offset:8704
  ds_read_b128 v[60:63], v238 offset:8192
  ds_read_b128 v[64:67], v238 offset:12288
  ds_read_b64_tr_b16 v[88:89], v243 offset:10240
  ds_read_b64_tr_b16 v[90:91], v243 offset:10752
  ds_read_b128 v[68:71], v239 offset:8192
  ds_read_b128 v[72:75], v239 offset:12288
  s_waitcnt lgkmcnt(12)
  v_mfma_f32_32x32x16_bf16 v[12:27], v[76:79], v[44:47], v[12:27]
  v_mfma_f32_32x32x16_bf16 v[28:43], v[76:79], v[48:51], v[28:43]
  s_waitcnt lgkmcnt(8)
  v_mfma_f32_32x32x16_bf16 v[12:27], v[80:83], v[52:55], v[12:27]
  v_mfma_f32_32x32x16_bf16 v[28:43], v[80:83], v[56:59], v[28:43]
  s_waitcnt lgkmcnt(0)
  s_barrier
  v_mfma_f32_32x32x16_bf16 v[12:27], v[84:87], v[60:63], v[12:27]
  ds_read_b64_tr_b16 v[76:77], v243 offset:16384
  ds_read_b64_tr_b16 v[78:79], v243 offset:16896
  ds_read_b128 v[44:47], v236 offset:0
  ds_read_b128 v[48:51], v236 offset:4096
  v_mfma_f32_32x32x16_bf16 v[28:43], v[84:87], v[64:67], v[28:43]
  ds_read_b64_tr_b16 v[80:81], v243 offset:18432
  ds_read_b64_tr_b16 v[82:83], v243 offset:18944
  ds_read_b128 v[52:55], v237 offset:0
  ds_read_b128 v[56:59], v237 offset:4096
  v_mfma_f32_32x32x16_bf16 v[12:27], v[88:91], v[68:71], v[12:27]
  v_mfma_f32_32x32x16_bf16 v[28:43], v[88:91], v[72:75], v[28:43]
  ds_read_b64_tr_b16 v[84:85], v243 offset:24576
  ds_read_b64_tr_b16 v[86:87], v243 offset:25088
  ds_read_b128 v[60:63], v236 offset:8192
  ds_read_b128 v[64:67], v236 offset:12288
  ds_read_b64_tr_b16 v[88:89], v243 offset:26624
  ds_read_b64_tr_b16 v[90:91], v243 offset:27136
  ds_read_b128 v[68:71], v237 offset:8192
  ds_read_b128 v[72:75], v237 offset:12288
  s_waitcnt lgkmcnt(12)
  v_mfma_f32_32x32x16_bf16 v[12:27], v[76:79], v[44:47], v[12:27]
  v_mfma_f32_32x32x16_bf16 v[28:43], v[76:79], v[48:51], v[28:43]
  s_waitcnt lgkmcnt(8)
  v_mfma_f32_32x32x16_bf16 v[12:27], v[80:83], v[52:55], v[12:27]
  v_mfma_f32_32x32x16_bf16 v[28:43], v[80:83], v[56:59], v[28:43]
  s_waitcnt lgkmcnt(0)
  s_barrier
  v_mfma_f32_32x32x16_bf16 v[12:27], v[84:87], v[60:63], v[12:27]
  ds_read_b64_tr_b16 v[76:77], v243 offset:32768
  ds_read_b64_tr_b16 v[78:79], v243 offset:33280
  ds_read_b128 v[44:47], v236 offset:16384
  ds_read_b128 v[48:51], v236 offset:20480
  v_mfma_f32_32x32x16_bf16 v[28:43], v[84:87], v[64:67], v[28:43]
  ds_read_b64_tr_b16 v[80:81], v243 offset:34816
  ds_read_b64_tr_b16 v[82:83], v243 offset:35328
  ds_read_b128 v[52:55], v237 offset:16384
  ds_read_b128 v[56:59], v237 offset:20480
  v_mfma_f32_32x32x16_bf16 v[12:27], v[88:91], v[68:71], v[12:27]
  v_mfma_f32_32x32x16_bf16 v[28:43], v[88:91], v[72:75], v[28:43]
  ds_read_b64_tr_b16 v[84:85], v243 offset:40960
  ds_read_b64_tr_b16 v[86:87], v243 offset:41472
  ds_read_b128 v[60:63], v236 offset:24576
  ds_read_b128 v[64:67], v236 offset:28672
  ds_read_b64_tr_b16 v[88:89], v243 offset:43008
  ds_read_b64_tr_b16 v[90:91], v243 offset:43520
  ds_read_b128 v[68:71], v237 offset:24576
  ds_read_b128 v[72:75], v237 offset:28672
  s_waitcnt lgkmcnt(12)
  v_mfma_f32_32x32x16_bf16 v[12:27], v[76:79], v[44:47], v[12:27]
  v_mfma_f32_32x32x16_bf16 v[28:43], v[76:79], v[48:51], v[28:43]
  s_waitcnt lgkmcnt(8)
  v_mfma_f32_32x32x16_bf16 v[12:27], v[80:83], v[52:55], v[12:27]
  v_mfma_f32_32x32x16_bf16 v[28:43], v[80:83], v[56:59], v[28:43]
  s_waitcnt lgkmcnt(0)
  v_mfma_f32_32x32x16_bf16 v[12:27], v[84:87], v[60:63], v[12:27]
  v_mfma_f32_32x32x16_bf16 v[28:43], v[84:87], v[64:67], v[28:43]
  v_mfma_f32_32x32x16_bf16 v[12:27], v[88:91], v[68:71], v[12:27]
  v_mfma_f32_32x32x16_bf16 v[28:43], v[88:91], v[72:75], v[28:43]
  s_cmp_eq_u32 s65, 1
  s_cbranch_scc1 s4_x1
  s_nop 7
  s_nop 1
  ds_write_b128 v247, v[28:31] offset:0
  ds_write_b128 v247, v[32:35] offset:1024
  ds_write_b128 v247, v[36:39] offset:2048
  ds_write_b128 v247, v[40:43] offset:3072
  s_branch s4_x2
s4_x1:
  s_nop 7
  s_nop 1
  ds_write_b128 v247, v[12:15] offset:0
  ds_write_b128 v247, v[16:19] offset:1024
  ds_write_b128 v247, v[20:23] offset:2048
  ds_write_b128 v247, v[24:27] offset:3072
  v_mov_b32 v12, v28
  v_mov_b32 v13, v29
  v_mov_b32 v14, v30
  v_mov_b32 v15, v31
  v_mov_b32 v16, v32
  v_mov_b32 v17, v33
  v_mov_b32 v18, v34
  v_mov_b32 v19, v35
  v_mov_b32 v20, v36
  v_mov_b32 v21, v37
  v_mov_b32 v22, v38
  v_mov_b32 v23, v39
  v_mov_b32 v24, v40
  v_mov_b32 v25, v41
  v_mov_b32 v26, v42
  v_mov_b32 v27, v43
s4_x2:
  v_xor_b32 v247, 4096, v247
  s_waitcnt lgkmcnt(0)
  s_barrier
  ds_read_b128 v[44:47], v247 offset:0
  ds_read_b128 v[48:51], v247 offset:1024
  ds_read_b128 v[52:55], v247 offset:2048
  ds_read_b128 v[56:59], v247 offset:3072
  s_waitcnt lgkmcnt(3)
  v_add_f32 v12, v12, v44
  v_add_f32 v13, v13, v45
  v_add_f32 v14, v14, v46
  v_add_f32 v15, v15, v47
  s_waitcnt lgkmcnt(2)
  v_add_f32 v16, v16, v48
  v_add_f32 v17, v17, v49
  v_add_f32 v18, v18, v50
  v_add_f32 v19, v19, v51
  s_waitcnt lgkmcnt(1)
  v_add_f32 v20, v20, v52
  v_add_f32 v21, v21, v53
  v_add_f32 v22, v22, v54
  v_add_f32 v23, v23, v55
  s_waitcnt lgkmcnt(0)
  v_add_f32 v24, v24, v56
  v_add_f32 v25, v25, v57
  v_add_f32 v26, v26, v58
  v_add_f32 v27, v27, v59
  v_cvt_pk_bf16_f32 v44, v12, v13
  v_cvt_pk_bf16_f32 v45, v14, v15
  ds_write_b64 v245, v[44:45] offset:49152
  v_cvt_pk_bf16_f32 v46, v16, v17
  v_cvt_pk_bf16_f32 v47, v18, v19
  ds_write_b64 v245, v[46:47] offset:49168
  v_cvt_pk_bf16_f32 v48, v20, v21
  v_cvt_pk_bf16_f32 v49, v22, v23
  ds_write_b64 v245, v[48:49] offset:49184
  v_cvt_pk_bf16_f32 v50, v24, v25
  v_cvt_pk_bf16_f32 v51, v26, v27
  ds_write_b64 v245, v[50:51] offset:49200
  s_lshl_b32 s67, s55, 16
  s_lshl_b32 s61, s56, 7
  s_add_u32 s67, s67, s61
  s_add_u32 s61, s67, 8192
  s_waitcnt lgkmcnt(0)
  s_barrier
  ds_read_b128 v[52:55], v246 offset:49152
  ds_read_b128 v[56:59], v246 offset:50304
  s_waitcnt lgkmcnt(0)
  v_lshlrev_b32 v60, 16, v52
  v_and_b32 v61, 0xffff0000, v52
  v_lshlrev_b32 v62, 16, v248
  v_and_b32 v63, 0xffff0000, v248
  v_add_f32 v60, v60, v62
  v_add_f32 v61, v61, v63
  v_cvt_pk_bf16_f32 v44, v60, v61
  v_lshlrev_b32 v60, 16, v53
  v_and_b32 v61, 0xffff0000, v53
  v_lshlrev_b32 v62, 16, v249
  v_and_b32 v63, 0xffff0000, v249
  v_add_f32 v60, v60, v62
  v_add_f32 v61, v61, v63
  v_cvt_pk_bf16_f32 v45, v60, v61
  v_lshlrev_b32 v60, 16, v54
  v_and_b32 v61, 0xffff0000, v54
  v_lshlrev_b32 v62, 16, v250
  v_and_b32 v63, 0xffff0000, v250
  v_add_f32 v60, v60, v62
  v_add_f32 v61, v61, v63
  v_cvt_pk_bf16_f32 v46, v60, v61
  v_lshlrev_b32 v60, 16, v55
  v_and_b32 v61, 0xffff0000, v55
  v_lshlrev_b32 v62, 16, v251
  v_and_b32 v63, 0xffff0000, v251
  v_add_f32 v60, v60, v62
  v_add_f32 v61, v61, v63
  v_cvt_pk_bf16_f32 v47, v60, v61
  v_lshlrev_b32 v60, 16, v56
  v_and_b32 v61, 0xffff0000, v56
  v_lshlrev_b32 v62, 16, v252
  v_and_b32 v63, 0xffff0000, v252
  v_add_f32 v60, v60, v62
  v_add_f32 v61, v61, v63
  v_cvt_pk_bf16_f32 v48, v60, v61
  v_lshlrev_b32 v60, 16, v57
  v_and_b32 v61, 0xffff0000, v57
  v_lshlrev_b32 v62, 16, v253
  v_and_b32 v63, 0xffff0000, v253
  v_add_f32 v60, v60, v62
  v_add_f32 v61, v61, v63
  v_cvt_pk_bf16_f32 v49, v60, v61
  v_lshlrev_b32 v60, 16, v58
  v_and_b32 v61, 0xffff0000, v58
  v_lshlrev_b32 v62, 16, v254
  v_and_b32 v63, 0xffff0000, v254
  v_add_f32 v60, v60, v62
  v_add_f32 v61, v61, v63
  v_cvt_pk_bf16_f32 v50, v60, v61
  v_lshlrev_b32 v60, 16, v59
  v_and_b32 v61, 0xffff0000, v59
  v_lshlrev_b32 v62, 16, v255
  v_and_b32 v63, 0xffff0000, v255
  v_add_f32 v60, v60, v62
  v_add_f32 v61, v61, v63
  v_cvt_pk_bf16_f32 v51, v60, v61
  buffer_store_dwordx4 v[44:47], v244, s[48:51], s67 offen
  buffer_store_dwordx4 v[48:51], v244, s[48:51], s61 offen
  s_endpgm
loader:
  s_sub_u32 s65, s52, 4
  v_lshrrev_b32 v1, 3, v0
  v_and_b32 v2, 7, v0
  v_lshlrev_b32 v6, 2, v0
  v_lshrrev_b32 v3, 1, v1
  s_lshl_b32 s62, s65, 1
  v_add_u32 v4, s62, v3
  v_and_b32 v4, 7, v4
  v_xor_b32 v4, v4, v2
  v_lshlrev_b32 v4, 4, v4
  s_lshl_b32 s62, s65, 2
  v_add_u32 v7, s62, v1
  v_lshl_add_u32 v7, v7, 10, v4
  v_xor_b32 v4, v3, v2
  v_lshlrev_b32 v4, 4, v4
  s_lshl_b32 s62, s65, 4
  v_add_u32 v10, s62, v1
  v_lshl_add_u32 v8, v10, 10, v4
  v_xor_b32 v9, 64, v8
  v_add_u32 v9, 7168, v9
  v_and_b32 v3, 1, v3
  v_lshlrev_b32 v3, 1, v3
  v_xor_b32 v3, v3, v2
  v_lshlrev_b32 v3, 4, v3
  v_mul_u32_u24 v10, 3072, v10
  v_add_u32 v10, v10, v3
  v_xor_b32 v11, 64, v10
  v_add_u32 v11, 24576, v11
  s_lshl_b32 s66, s65, 9
  s_lshl_b32 s67, s65, 11
  s_add_u32 s67, s67, 2048
  s_mul_i32 s68, s65, 6144
  s_add_u32 s68, s68, 10240
  s_lshl_b32 s70, s53, 16
  s_sub_u32 s69, s70, 16384
  s_cmp_eq_u32 s53, 0
  s_cselect_b32 s69, 0, s69
  s_lshl_b32 s71, s54, 7
  s_mul_i32 s61, s53, 2
  s_and_b32 s61, s61, 7
  s_lshl_b32 s61, s61, 7
  s_add_u32 s70, s70, s61
  s_add_u32 s69, s69, s61
  s_mul_i32 s61, s61, 1536
  s_add_u32 s71, s71, s61
  s_waitcnt lgkmcnt(0)
  s_mov_b32 s36, s16
  s_mov_b32 s37, s17
  s_mov_b32 s38, 2097152
  s_mov_b32 s39, 0x20000
  s_mov_b32 s40, s18
  s_mov_b32 s41, s19
  s_mov_b32 s42, 1572864
  s_mov_b32 s43, 0x20000
  s_mov_b32 s44, s34
  s_mov_b32 s45, s35
  s_mov_b32 s46, 18874368
  s_mov_b32 s47, 0x20000
  s_add_u32 m0, s67, 0
  s_nop 0
  buffer_load_dwordx4 v8, s[36:39], s70 offen lds
  buffer_load_dwordx4 v9, s[36:39], s70 offen offset:1024 lds
  s_add_u32 m0, s68, 0
  s_nop 0
  buffer_load_dwordx4 v10, s[40:43], s71 offen offset:0 lds
  buffer_load_dwordx4 v10, s[40:43], s71 offen offset:1024 lds
  buffer_load_dwordx4 v10, s[40:43], s71 offen offset:2048 lds
  s_add_u32 m0, m0, 3072
  s_nop 0
  buffer_load_dwordx4 v11, s[40:43], s71 offen offset:0 lds
  buffer_load_dwordx4 v11, s[40:43], s71 offen offset:1024 lds
  buffer_load_dwordx4 v11, s[40:43], s71 offen offset:2048 lds
  s_add_u32 m0, s66, 0
  s_mov_b32 exec_hi, 0
  buffer_load_dwordx4 v7, s[36:39], s69 offen lds
  s_mov_b32 exec_hi, -1
  s_add_u32 s61, s70, 128
  s_and_b32 s61, s61, 0x380
  s_andn2_b32 s70, s70, 0x380
  s_or_b32 s70, s70, s61
  s_andn2_b32 s69, s69, 0x380
  s_or_b32 s69, s69, s61
  s_mul_i32 s71, s61, 1536
  s_lshl_b32 s61, s54, 7
  s_add_u32 s71, s71, s61
  s_and_b32 s78, s65, 1
  s_lshl_b32 s78, s78, 1
  v_lshlrev_b32 v58, 7, v0
  v_lshrrev_b32 v3, 1, v1
  v_xor_b32 v4, v3, v2
  v_lshlrev_b32 v4, 4, v4
  s_lshl_b32 s62, s78, 4
  v_add_u32 v5, s62, v1
  v_mul_u32_u24 v52, 128, v5
  v_xor_b32 v53, 64, v4
  v_add_u32 v53, v53, v52
  v_add_u32 v53, 0, v53
  v_add_u32 v52, v52, v4
  v_and_b32 v3, 1, v3
  v_lshlrev_b32 v3, 2, v3
  v_xor_b32 v3, v3, v2
  v_lshlrev_b32 v3, 4, v3
  v_lshl_add_u32 v54, v5, 10, v3
  v_add_u32 v55, 7168, v54
  s_lshl_b32 s75, s78, 11
  s_lshl_b32 s77, s56, 7
  v_lshrrev_b32 v3, 4, v0
  v_lshlrev_b32 v4, 2, v3
  v_and_b32 v5, 15, v0
  v_xor_b32 v4, v4, v5
  v_lshlrev_b32 v4, 4, v4
  s_lshl_b32 s62, s65, 4
  v_add_u32 v3, s62, v3
  v_mul_u32_u24 v3, 3584, v3
  v_add_u32 v44, v3, v4
  v_add_u32 v45, 13312, v44
  v_add_u32 v46, 26624, v44
  v_add_u32 v47, 39936, v44
  v_lshrrev_b32 v3, 4, v0
  v_lshlrev_b32 v4, 2, v3
  v_and_b32 v5, 15, v0
  v_xor_b32 v4, v4, v5
  v_lshlrev_b32 v4, 4, v4
  s_lshl_b32 s62, s78, 4
  v_add_u32 v3, s62, v3
  v_mul_u32_u24 v3, 3584, v3
  v_add_u32 v12, v3, v4
  v_add_u32 v13, 13312, v12
  v_add_u32 v14, 26624, v12
  v_add_u32 v15, 39936, v12
  v_lshrrev_b32 v3, 1, v1
  v_xor_b32 v4, v3, v2
  v_lshlrev_b32 v4, 4, v4
  s_lshl_b32 s62, s65, 5
  v_add_u32 v3, s62, v1
  v_lshl_add_u32 v48, v3, 10, v4
  v_xor_b32 v49, 64, v48
  v_add_u32 v49, 7168, v49
  v_add_u32 v50, 14336, v48
  v_add_u32 v51, 14336, v49
  s_lshr_b32 s62, s65, 1
  s_lshl_b32 s62, s62, 16
  s_and_b32 s63, s65, 1
  s_lshl_b32 s63, s63, 12
  s_add_u32 s62, s62, s63
  v_lshl_add_u32 v48, v1, 7, v4
  v_add_u32 v48, s62, v48
  v_xor_b32 v49, 64, v48
  v_mov_b32 v50, v48
  v_mov_b32 v51, v49
  s_sleep 0
  s_add_u32 m0, s67, 34816
  s_nop 0
  buffer_load_dwordx4 v8, s[36:39], s70 offen lds
  buffer_load_dwordx4 v9, s[36:39], s70 offen offset:1024 lds
  s_add_u32 m0, s68, 34816
  s_nop 0
  buffer_load_dwordx4 v10, s[40:43], s71 offen offset:0 lds
  buffer_load_dwordx4 v10, s[40:43], s71 offen offset:1024 lds
  buffer_load_dwordx4 v10, s[40:43], s71 offen offset:2048 lds
  s_add_u32 m0, m0, 3072
  s_nop 0
  buffer_load_dwordx4 v11, s[40:43], s71 offen offset:0 lds
  buffer_load_dwordx4 v11, s[40:43], s71 offen offset:1024 lds
  buffer_load_dwordx4 v11, s[40:43], s71 offen offset:2048 lds
  s_add_u32 m0, s66, 34816
  s_mov_b32 exec_hi, 0
  buffer_load_dwordx4 v7, s[36:39], s69 offen lds
  s_mov_b32 exec_hi, -1
  s_add_u32 s61, s70, 128
  s_and_b32 s61, s61, 0x380
  s_andn2_b32 s70, s70, 0x380
  s_or_b32 s70, s70, s61
  s_andn2_b32 s69, s69, 0x380
  s_or_b32 s69, s69, s61
  s_mul_i32 s71, s61, 1536
  s_lshl_b32 s61, s54, 7
  s_add_u32 s71, s71, s61
  s_add_u32 m0, s67, 69632
  s_nop 0
  buffer_load_dwordx4 v8, s[36:39], s70 offen lds
  buffer_load_dwordx4 v9, s[36:39], s70 offen offset:1024 lds
  s_add_u32 m0, s68, 69632
  s_nop 0
  buffer_load_dwordx4 v10, s[40:43], s71 offen offset:0 lds
  buffer_load_dwordx4 v10, s[40:43], s71 offen offset:1024 lds
  buffer_load_dwordx4 v10, s[40:43], s71 offen offset:2048 lds
  s_add_u32 m0, m0, 3072
  s_nop 0
  buffer_load_dwordx4 v11, s[40:43], s71 offen offset:0 lds
  buffer_load_dwordx4 v11, s[40:43], s71 offen offset:1024 lds
  buffer_load_dwordx4 v11, s[40:43], s71 offen offset:2048 lds
  s_add_u32 m0, s66, 69632
  s_mov_b32 exec_hi, 0
  buffer_load_dwordx4 v7, s[36:39], s69 offen lds
  s_mov_b32 exec_hi, -1
  s_add_u32 s61, s70, 128
  s_and_b32 s61, s61, 0x380
  s_andn2_b32 s70, s70, 0x380
  s_or_b32 s70, s70, s61
  s_andn2_b32 s69, s69, 0x380
  s_or_b32 s69, s69, s61
  s_mul_i32 s71, s61, 1536
  s_lshl_b32 s61, s54, 7
  s_add_u32 s71, s71, s61
  s_lshl_b32 s61, s53, 5
  s_add_u32 s61, s61, s54
  s_add_u32 s61, s61, 117760
  s_lshl_b32 s61, s61, 7
  s_mov_b64 exec, 0xff
  v_lshlrev_b32 v3, 4, v0
  v_mov_b32 v36, 0
  v_mov_b32 v37, 0
  v_mov_b32 v38, 0
  v_mov_b32 v39, 0
  buffer_store_dwordx4 v[36:39], v3, s[44:47], s61 offen
  s_mov_b64 exec, -1
  s_waitcnt vmcnt(19)
  s_barrier
  s_add_u32 m0, s67, 104448
  s_nop 0
  buffer_load_dwordx4 v8, s[36:39], s70 offen lds
  buffer_load_dwordx4 v9, s[36:39], s70 offen offset:1024 lds
  s_add_u32 m0, s68, 104448
  s_nop 0
  buffer_load_dwordx4 v10, s[40:43], s71 offen offset:0 lds
  buffer_load_dwordx4 v10, s[40:43], s71 offen offset:1024 lds
  buffer_load_dwordx4 v10, s[40:43], s71 offen offset:2048 lds
  s_add_u32 m0, m0, 3072
  s_nop 0
  buffer_load_dwordx4 v11, s[40:43], s71 offen offset:0 lds
  buffer_load_dwordx4 v11, s[40:43], s71 offen offset:1024 lds
  buffer_load_dwordx4 v11, s[40:43], s71 offen offset:2048 lds
  s_add_u32 m0, s66, 104448
  s_mov_b32 exec_hi, 0
  buffer_load_dwordx4 v7, s[36:39], s69 offen lds
  s_mov_b32 exec_hi, -1
  s_add_u32 s61, s70, 128
  s_and_b32 s61, s61, 0x380
  s_andn2_b32 s70, s70, 0x380
  s_or_b32 s70, s70, s61
  s_andn2_b32 s69, s69, 0x380
  s_or_b32 s69, s69, s61
  s_mul_i32 s71, s61, 1536
  s_lshl_b32 s61, s54, 7
  s_add_u32 s71, s71, s61
  s_waitcnt vmcnt(19)
  s_barrier
  s_add_u32 m0, s67, 0
  s_nop 0
  buffer_load_dwordx4 v8, s[36:39], s70 offen lds
  buffer_load_dwordx4 v9, s[36:39], s70 offen offset:1024 lds
  s_add_u32 m0, s68, 0
  s_nop 0
  buffer_load_dwordx4 v10, s[40:43], s71 offen offset:0 lds
  buffer_load_dwordx4 v10, s[40:43], s71 offen offset:1024 lds
  buffer_load_dwordx4 v10, s[40:43], s71 offen offset:2048 lds
  s_add_u32 m0, m0, 3072
  s_nop 0
  buffer_load_dwordx4 v11, s[40:43], s71 offen offset:0 lds
  buffer_load_dwordx4 v11, s[40:43], s71 offen offset:1024 lds
  buffer_load_dwordx4 v11, s[40:43], s71 offen offset:2048 lds
  s_add_u32 m0, s66, 0
  s_mov_b32 exec_hi, 0
  buffer_load_dwordx4 v7, s[36:39], s69 offen lds
  s_mov_b32 exec_hi, -1
  s_add_u32 s61, s70, 128
  s_and_b32 s61, s61, 0x380
  s_andn2_b32 s70, s70, 0x380
  s_or_b32 s70, s70, s61
  s_andn2_b32 s69, s69, 0x380
  s_or_b32 s69, s69, s61
  s_mul_i32 s71, s61, 1536
  s_lshl_b32 s61, s54, 7
  s_add_u32 s71, s71, s61
  s_waitcnt vmcnt(19)
  s_barrier
  v_mov_b32 v3, 0
  global_load_dwordx2 v[16:17], v3, s[32:33]
  s_add_u32 m0, s67, 34816
  s_nop 0
  buffer_load_dwordx4 v8, s[36:39], s70 offen lds
  buffer_load_dwordx4 v9, s[36:39], s70 offen offset:1024 lds
  s_add_u32 m0, s68, 34816
  s_nop 0
  buffer_load_dwordx4 v10, s[40:43], s71 offen offset:0 lds
  buffer_load_dwordx4 v10, s[40:43], s71 offen offset:1024 lds
  buffer_load_dwordx4 v10, s[40:43], s71 offen offset:2048 lds
  s_add_u32 m0, m0, 3072
  s_nop 0
  buffer_load_dwordx4 v11, s[40:43], s71 offen offset:0 lds
  buffer_load_dwordx4 v11, s[40:43], s71 offen offset:1024 lds
  buffer_load_dwordx4 v11, s[40:43], s71 offen offset:2048 lds
  s_add_u32 m0, s66, 34816
  s_mov_b32 exec_hi, 0
  buffer_load_dwordx4 v7, s[36:39], s69 offen lds
  s_mov_b32 exec_hi, -1
  s_add_u32 s61, s70, 128
  s_and_b32 s61, s61, 0x380
  s_andn2_b32 s70, s70, 0x380
  s_or_b32 s70, s70, s61
  s_andn2_b32 s69, s69, 0x380
  s_or_b32 s69, s69, s61
  s_mul_i32 s71, s61, 1536
  s_lshl_b32 s61, s54, 7
  s_add_u32 s71, s71, s61
  s_waitcnt vmcnt(19)
  s_barrier
  s_add_u32 m0, s67, 69632
  s_nop 0
  buffer_load_dwordx4 v8, s[36:39], s70 offen lds
  buffer_load_dwordx4 v9, s[36:39], s70 offen offset:1024 lds
  s_add_u32 m0, s68, 69632
  s_nop 0
  buffer_load_dwordx4 v10, s[40:43], s71 offen offset:0 lds
  buffer_load_dwordx4 v10, s[40:43], s71 offen offset:1024 lds
  buffer_load_dwordx4 v10, s[40:43], s71 offen offset:2048 lds
  s_add_u32 m0, m0, 3072
  s_nop 0
  buffer_load_dwordx4 v11, s[40:43], s71 offen offset:0 lds
  buffer_load_dwordx4 v11, s[40:43], s71 offen offset:1024 lds
  buffer_load_dwordx4 v11, s[40:43], s71 offen offset:2048 lds
  s_add_u32 m0, s66, 69632
  s_mov_b32 exec_hi, 0
  buffer_load_dwordx4 v7, s[36:39], s69 offen lds
  s_mov_b32 exec_hi, -1
  s_add_u32 s61, s70, 128
  s_and_b32 s61, s61, 0x380
  s_andn2_b32 s70, s70, 0x380
  s_or_b32 s70, s70, s61
  s_andn2_b32 s69, s69, 0x380
  s_or_b32 s69, s69, s61
  s_mul_i32 s71, s61, 1536
  s_lshl_b32 s61, s54, 7
  s_add_u32 s71, s71, s61
  s_waitcnt vmcnt(19)
  s_barrier
  s_add_u32 m0, s67, 104448
  s_nop 0
  buffer_load_dwordx4 v8, s[36:39], s70 offen lds
  buffer_load_dwordx4 v9, s[36:39], s70 offen offset:1024 lds
  s_add_u32 m0, s68, 104448
  s_nop 0
  buffer_load_dwordx4 v10, s[40:43], s71 offen offset:0 lds
  buffer_load_dwordx4 v10, s[40:43], s71 offen offset:1024 lds
  buffer_load_dwordx4 v10, s[40:43], s71 offen offset:2048 lds
  s_add_u32 m0, m0, 3072
  s_nop 0
  buffer_load_dwordx4 v11, s[40:43], s71 offen offset:0 lds
  buffer_load_dwordx4 v11, s[40:43], s71 offen offset:1024 lds
  buffer_load_dwordx4 v11, s[40:43], s71 offen offset:2048 lds
  s_add_u32 m0, s66, 104448
  s_mov_b32 exec_hi, 0
  buffer_load_dwordx4 v7, s[36:39], s69 offen lds
  s_mov_b32 exec_hi, -1
  s_add_u32 s61, s70, 128
  s_and_b32 s61, s61, 0x380
  s_andn2_b32 s70, s70, 0x380
  s_or_b32 s70, s70, s61
  s_andn2_b32 s69, s69, 0x380
  s_or_b32 s69, s69, s61
  s_mul_i32 s71, s61, 1536
  s_lshl_b32 s61, s54, 7
  s_add_u32 s71, s71, s61
  s_min_u32 s70, s58, 13
  s_lshl_b32 s70, s70, 8
  s_lshl_b32 s71, s57, 17
  s_add_u32 s71, s71, 2097152
  s_lshl_b32 s76, s55, 16
  s_mov_b32 s36, s24
  s_mov_b32 s37, s25
  s_mov_b32 s38, 1835008
  s_mov_b32 s39, 0x20000
  s_mov_b32 s40, s26
  s_mov_b32 s41, s27
  s_mov_b32 s42, 1835008
  s_mov_b32 s43, 0x20000
  s_waitcnt vmcnt(27)
  s_mov_b32 s64, 32768
tag_14:
  v_readfirstlane_b32 s22, v16
  v_readfirstlane_b32 s23, v17
  s_nop 1
  s_cmp_lg_u32 s22, 0
  s_cbranch_scc1 tagd_15
  v_mov_b32 v3, 0
  global_load_dwordx2 v[16:17], v3, s[32:33] sc1
  s_waitcnt vmcnt(0)
  s_sub_u32 s64, s64, 1
  s_cbranch_scc0 tag_14
tagd_15:
  s_nop 4
  s_cmp_ge_u32 s65, 2
  s_cbranch_scc1 l_stream
  s_mov_b32 s48, s20
  s_mov_b32 s49, s21
  s_mov_b32 s50, 524288
  s_mov_b32 s51, 0x20000
  s_waitcnt vmcnt(18)
  s_barrier
  s_waitcnt vmcnt(9)
  s_barrier
  s_add_u32 m0, s75, 0
  s_add_u32 s79, s77, 16384
  buffer_load_dwordx4 v54, s[48:51], s77 offen lds
  buffer_load_dwordx4 v55, s[48:51], s77 offen offset:1024 lds
  s_add_u32 m0, m0, 2048
  s_nop 0
  buffer_load_dwordx4 v54, s[48:51], s79 offen lds
  buffer_load_dwordx4 v55, s[48:51], s79 offen offset:1024 lds
  s_add_u32 s77, s77, 65536
  s_add_u32 m0, s75, 8192
  s_add_u32 s79, s77, 16384
  buffer_load_dwordx4 v54, s[48:51], s77 offen lds
  buffer_load_dwordx4 v55, s[48:51], s77 offen offset:1024 lds
  s_add_u32 m0, m0, 2048
  s_nop 0
  buffer_load_dwordx4 v54, s[48:51], s79 offen lds
  buffer_load_dwordx4 v55, s[48:51], s79 offen offset:1024 lds
  s_add_u32 s77, s77, 65536
  s_add_u32 m0, s75, 16384
  s_add_u32 s79, s77, 16384
  buffer_load_dwordx4 v54, s[48:51], s77 offen lds
  buffer_load_dwordx4 v55, s[48:51], s77 offen offset:1024 lds
  s_add_u32 m0, m0, 2048
  s_nop 0
  buffer_load_dwordx4 v54, s[48:51], s79 offen lds
  buffer_load_dwordx4 v55, s[48:51], s79 offen offset:1024 lds
  s_add_u32 s77, s77, 65536
  s_add_u32 m0, s75, 24576
  s_add_u32 s79, s77, 16384
  buffer_load_dwordx4 v54, s[48:51], s77 offen lds
  buffer_load_dwordx4 v55, s[48:51], s77 offen offset:1024 lds
  s_add_u32 m0, m0, 2048
  s_nop 0
  buffer_load_dwordx4 v54, s[48:51], s79 offen lds
  buffer_load_dwordx4 v55, s[48:51], s79 offen offset:1024 lds
  s_add_u32 s77, s77, 65536
  s_waitcnt vmcnt(16)
  s_barrier
  s_add_u32 m0, s75, 32768
  s_add_u32 s79, s77, 16384
  buffer_load_dwordx4 v54, s[48:51], s77 offen lds
  buffer_load_dwordx4 v55, s[48:51], s77 offen offset:1024 lds
  s_add_u32 m0, m0, 2048
  s_nop 0
  buffer_load_dwordx4 v54, s[48:51], s79 offen lds
  buffer_load_dwordx4 v55, s[48:51], s79 offen offset:1024 lds
  s_add_u32 s77, s77, 65536
  s_add_u32 m0, s75, 40960
  s_add_u32 s79, s77, 16384
  buffer_load_dwordx4 v54, s[48:51], s77 offen lds
  buffer_load_dwordx4 v55, s[48:51], s77 offen offset:1024 lds
  s_add_u32 m0, m0, 2048
  s_nop 0
  buffer_load_dwordx4 v54, s[48:51], s79 offen lds
  buffer_load_dwordx4 v55, s[48:51], s79 offen offset:1024 lds
  s_add_u32 s77, s77, 65536
  s_add_u32 m0, s75, 49152
  s_add_u32 s79, s77, 16384
  buffer_load_dwordx4 v54, s[48:51], s77 offen lds
  buffer_load_dwordx4 v55, s[48:51], s77 offen offset:1024 lds
  s_add_u32 m0, m0, 2048
  s_nop 0
  buffer_load_dwordx4 v54, s[48:51], s79 offen lds
  buffer_load_dwordx4 v55, s[48:51], s79 offen offset:1024 lds
  s_add_u32 s77, s77, 65536
  s_add_u32 m0, s75, 57344
  s_add_u32 s79, s77, 16384
  buffer_load_dwordx4 v54, s[48:51], s77 offen lds
  buffer_load_dwordx4 v55, s[48:51], s77 offen offset:1024 lds
  s_add_u32 m0, m0, 2048
  s_nop 0
  buffer_load_dwordx4 v54, s[48:51], s79 offen lds
  buffer_load_dwordx4 v55, s[48:51], s79 offen offset:1024 lds
  s_add_u32 s77, s77, 65536
  s_barrier
  s_waitcnt vmcnt(0)
  s_barrier
  s_barrier
  s_lshl_b32 s61, s53, 5
  s_add_u32 s61, s61, s54
  s_lshl_b32 s61, s61, 7
  s_add_u32 s61, s61, 15073280
  s_xor_b32 s61, s61, 0
  s_cmp_lg_u32 s65, 0
  s_barrier
  s_cbranch_scc1 nf1
  s_mov_b64 exec, 0xff
  v_lshlrev_b32 v3, 4, v0
  v_mov_b32 v32, s22
  v_mov_b32 v33, s23
  v_mov_b32 v34, s22
  v_mov_b32 v35, s23
  buffer_store_dwordx4 v[32:35], v3, s[44:47], s61 offen
  buffer_store_dwordx4 v[32:35], v3, s[44:47], s61 offen offset:2048 sc1
  s_mov_b64 exec, -1
nf1:
  s_and_b32 s61, s55, 1
  s_lshl_b32 s61, s61, 3
  s_add_u32 s61, s61, s56
  s_lshl_b32 s62, s57, 5
  s_add_u32 s61, s61, s62
  s_add_u32 s61, s61, 116736
  s_lshl_b32 s61, s61, 7
  s_mov_b64 exec, 0xff
  v_lshlrev_b32 v3, 4, v0
  v_mov_b32 v36, 0
  v_mov_b32 v37, 0
  v_mov_b32 v38, 0
  v_mov_b32 v39, 0
  buffer_store_dwordx4 v[36:39], v3, s[44:47], s61 offen
  s_mov_b64 exec, -1
  s_barrier
  s_add_u32 m0, s75, 98304
  s_add_u32 s79, s76, 2048
  buffer_load_dwordx4 v52, s[44:47], s76 offen sc1 lds
  buffer_load_dwordx4 v53, s[44:47], s76 offen offset:1024 sc1 lds
  s_add_u32 m0, m0, 2048
  s_nop 0
  buffer_load_dwordx4 v52, s[44:47], s79 offen sc1 lds
  buffer_load_dwordx4 v53, s[44:47], s79 offen offset:1024 sc1 lds
  s_add_u32 s76, s76, 8192
  s_add_u32 m0, s75, 106496
  s_add_u32 s79, s76, 2048
  buffer_load_dwordx4 v52, s[44:47], s76 offen sc1 lds
  buffer_load_dwordx4 v53, s[44:47], s76 offen offset:1024 sc1 lds
  s_add_u32 m0, m0, 2048
  s_nop 0
  buffer_load_dwordx4 v52, s[44:47], s79 offen sc1 lds
  buffer_load_dwordx4 v53, s[44:47], s79 offen offset:1024 sc1 lds
  s_add_u32 s76, s76, 8192
  s_add_u32 m0, s75, 114688
  s_add_u32 s79, s76, 2048
  buffer_load_dwordx4 v52, s[44:47], s76 offen sc1 lds
  buffer_load_dwordx4 v53, s[44:47], s76 offen offset:1024 sc1 lds
  s_add_u32 m0, m0, 2048
  s_nop 0
  buffer_load_dwordx4 v52, s[44:47], s79 offen sc1 lds
  buffer_load_dwordx4 v53, s[44:47], s79 offen offset:1024 sc1 lds
  s_add_u32 s76, s76, 8192
  s_add_u32 m0, s75, 122880
  s_add_u32 s79, s76, 2048
  buffer_load_dwordx4 v52, s[44:47], s76 offen sc1 lds
  buffer_load_dwordx4 v53, s[44:47], s76 offen offset:1024 sc1 lds
  s_add_u32 m0, m0, 2048
  s_nop 0
  buffer_load_dwordx4 v52, s[44:47], s79 offen sc1 lds
  buffer_load_dwordx4 v53, s[44:47], s79 offen offset:1024 sc1 lds
  s_add_u32 s76, s76, 8192
  s_add_u32 m0, s75, 131072
  s_add_u32 s79, s76, 2048
  buffer_load_dwordx4 v52, s[44:47], s76 offen sc1 lds
  buffer_load_dwordx4 v53, s[44:47], s76 offen offset:1024 sc1 lds
  s_add_u32 m0, m0, 2048
  s_nop 0
  buffer_load_dwordx4 v52, s[44:47], s79 offen sc1 lds
  buffer_load_dwordx4 v53, s[44:47], s79 offen offset:1024 sc1 lds
  s_add_u32 s76, s76, 8192
  s_add_u32 m0, s75, 139264
  s_add_u32 s79, s76, 2048
  buffer_load_dwordx4 v52, s[44:47], s76 offen sc1 lds
  buffer_load_dwordx4 v53, s[44:47], s76 offen offset:1024 sc1 lds
  s_add_u32 m0, m0, 2048
  s_nop 0
  buffer_load_dwordx4 v52, s[44:47], s79 offen sc1 lds
  buffer_load_dwordx4 v53, s[44:47], s79 offen offset:1024 sc1 lds
  s_add_u32 s76, s76, 8192
  s_add_u32 m0, s75, 147456
  s_add_u32 s79, s76, 2048
  buffer_load_dwordx4 v52, s[44:47], s76 offen sc1 lds
  buffer_load_dwordx4 v53, s[44:47], s76 offen offset:1024 sc1 lds
  s_add_u32 m0, m0, 2048
  s_nop 0
  buffer_load_dwordx4 v52, s[44:47], s79 offen sc1 lds
  buffer_load_dwordx4 v53, s[44:47], s79 offen offset:1024 sc1 lds
  s_add_u32 s76, s76, 8192
  s_add_u32 m0, s75, 155648
  s_add_u32 s79, s76, 2048
  buffer_load_dwordx4 v52, s[44:47], s76 offen sc1 lds
  buffer_load_dwordx4 v53, s[44:47], s76 offen offset:1024 sc1 lds
  s_add_u32 m0, m0, 2048
  s_nop 0
  buffer_load_dwordx4 v52, s[44:47], s79 offen sc1 lds
  buffer_load_dwordx4 v53, s[44:47], s79 offen offset:1024 sc1 lds
  s_add_u32 s76, s76, 8192
  s_waitcnt vmcnt(24)
  s_barrier
  s_waitcnt vmcnt(16)
  s_barrier
  s_waitcnt vmcnt(8)
  s_barrier
  s_waitcnt vmcnt(0)
  s_barrier
  s_add_u32 s70, s70, 688128
  s_and_b32 s61, s55, 1
  s_lshl_b32 s61, s61, 3
  s_add_u32 s61, s61, s56
  s_lshl_b32 s62, s57, 5
  s_add_u32 s61, s61, s62
  s_lshl_b32 s61, s61, 7
  s_add_u32 s61, s61, 14942208
  s_xor_b32 s61, s61, 0
  s_cmp_lg_u32 s65, 0
  s_barrier
  s_barrier
  s_cbranch_scc1 l_join
  s_mov_b64 exec, 0xff
  v_lshlrev_b32 v3, 4, v0
  v_mov_b32 v32, s22
  v_mov_b32 v33, s23
  v_mov_b32 v34, s22
  v_mov_b32 v35, s23
  buffer_store_dwordx4 v[32:35], v3, s[44:47], s61 offen
  buffer_store_dwordx4 v[32:35], v3, s[44:47], s61 offen offset:2048 sc1
  s_mov_b64 exec, -1
  s_branch l_join
l_stream:
  s_lshl_b32 s72, s2, 1
  s_add_u32 s72, s72, s65
  s_sub_u32 s72, s72, 2
  s_lshr_b32 s73, s72, 3
  s_and_b32 s74, s72, 7
  s_min_u32 s73, s73, 55
  s_cmp_ge_u32 s73, 28
  s_cselect_b32 s48, s26, s24
  s_cselect_b32 s49, s27, s25
  s_mov_b32 s50, 1835008
  s_mov_b32 s51, 0x20000
  s_sub_u32 s61, s73, 28
  s_cselect_b32 s61, s73, s61
  s_lshl_b32 s61, s61, 7
  s_mul_i32 s62, s74, 229376
  s_add_u32 s61, s61, s62
  v_lshrrev_b32 v3, 4, v0
  v_and_b32 v4, 1, v0
  v_lshl_add_u32 v3, v3, 1, v4
  v_mul_u32_u24 v3, 3584, v3
  v_bfe_u32 v4, v0, 1, 3
  v_lshl_add_u32 v3, v4, 4, v3
  s_cmp_eq_u32 s65, 3
  s_cselect_b32 s16, s26, s24
  s_cselect_b32 s17, s27, s25
  s_mov_b32 s18, 1835008
  s_mov_b32 s19, 0x20000
  s_mul_i32 s68, s59, 7168
  s_add_u32 s68, s68, 0
  s_lshl_b32 s69, s78, 12
  s_waitcnt vmcnt(18)
  s_barrier
  buffer_load_dwordx4 v[60:63], v3, s[48:51], s61 offen
  s_add_u32 s61, s61, 28672
  buffer_load_dwordx4 v[64:67], v3, s[48:51], s61 offen
  s_add_u32 s61, s61, 28672
  buffer_load_dwordx4 v[68:71], v3, s[48:51], s61 offen
  s_add_u32 s61, s61, 28672
  buffer_load_dwordx4 v[72:75], v3, s[48:51], s61 offen
  s_add_u32 s61, s61, 28672
  buffer_load_dwordx4 v[76:79], v3, s[48:51], s61 offen
  s_add_u32 s61, s61, 28672
  buffer_load_dwordx4 v[80:83], v3, s[48:51], s61 offen
  s_add_u32 s61, s61, 28672
  buffer_load_dwordx4 v[84:87], v3, s[48:51], s61 offen
  s_add_u32 s61, s61, 28672
  buffer_load_dwordx4 v[88:91], v3, s[48:51], s61 offen
  s_waitcnt vmcnt(17)
  s_barrier
  s_waitcnt vmcnt(8)
  s_barrier
  s_mov_b32 exec_hi, 0xffffff
  buffer_load_dword v59, v58, s[16:19], s68 offen
  s_mov_b32 exec_hi, -1
  s_add_u32 s68, s68, 229376
  s_barrier
  s_mov_b32 exec_hi, 0xffffff
  buffer_load_dword v59, v58, s[16:19], s68 offen
  s_mov_b32 exec_hi, -1
  s_add_u32 s68, s68, 229376
  s_barrier
  s_barrier
  s_add_u32 m0, s69, 65536
  s_add_u32 s79, s70, 57344
  buffer_load_dwordx4 v12, s[36:39], s70 offen offset:0 lds
  buffer_load_dwordx4 v13, s[36:39], s70 offen offset:1024 lds
  buffer_load_dwordx4 v14, s[36:39], s70 offen offset:2048 lds
  buffer_load_dwordx4 v15, s[36:39], s70 offen offset:3072 lds
  s_add_u32 m0, m0, 16384
  s_nop 0
  buffer_load_dwordx4 v12, s[40:43], s70 offen offset:0 lds
  buffer_load_dwordx4 v13, s[40:43], s70 offen offset:1024 lds
  buffer_load_dwordx4 v14, s[40:43], s70 offen offset:2048 lds
  buffer_load_dwordx4 v15, s[40:43], s70 offen offset:3072 lds
  s_add_u32 m0, s69, 69632
  s_add_u32 s79, s70, 57344
  buffer_load_dwordx4 v12, s[36:39], s79 offen offset:0 lds
  buffer_load_dwordx4 v13, s[36:39], s79 offen offset:1024 lds
  buffer_load_dwordx4 v14, s[36:39], s79 offen offset:2048 lds
  buffer_load_dwordx4 v15, s[36:39], s79 offen offset:3072 lds
  s_add_u32 m0, m0, 16384
  s_nop 0
  buffer_load_dwordx4 v12, s[40:43], s79 offen offset:0 lds
  buffer_load_dwordx4 v13, s[40:43], s79 offen offset:1024 lds
  buffer_load_dwordx4 v14, s[40:43], s79 offen offset:2048 lds
  buffer_load_dwordx4 v15, s[40:43], s79 offen offset:3072 lds
  s_add_u32 s70, s70, 229376
  s_mov_b32 exec_hi, 0xffffff
  buffer_load_dword v59, v58, s[16:19], s68 offen
  s_mov_b32 exec_hi, -1
  s_add_u32 s68, s68, 229376
  s_barrier
  s_waitcnt vmcnt(19)
  v_lshlrev_b32 v28, 16, v60
  v_and_b32 v29, 0xffff0000, v60
  v_lshlrev_b32 v30, 16, v61
  v_and_b32 v31, 0xffff0000, v61
  v_lshlrev_b32 v32, 16, v62
  v_and_b32 v33, 0xffff0000, v62
  v_lshlrev_b32 v34, 16, v63
  v_and_b32 v35, 0xffff0000, v63
  v_lshlrev_b32 v36, 16, v64
  v_and_b32 v37, 0xffff0000, v64
  v_add_f32 v28, v28, v36
  v_add_f32 v29, v29, v37
  v_lshlrev_b32 v36, 16, v65
  v_and_b32 v37, 0xffff0000, v65
  v_add_f32 v30, v30, v36
  v_add_f32 v31, v31, v37
  v_lshlrev_b32 v36, 16, v66
  v_and_b32 v37, 0xffff0000, v66
  v_add_f32 v32, v32, v36
  v_add_f32 v33, v33, v37
  v_lshlrev_b32 v36, 16, v67
  v_and_b32 v37, 0xffff0000, v67
  v_add_f32 v34, v34, v36
  v_add_f32 v35, v35, v37
  v_lshlrev_b32 v36, 16, v68
  v_and_b32 v37, 0xffff0000, v68
  v_add_f32 v28, v28, v36
  v_add_f32 v29, v29, v37
  v_lshlrev_b32 v36, 16, v69
  v_and_b32 v37, 0xffff0000, v69
  v_add_f32 v30, v30, v36
  v_add_f32 v31, v31, v37
  v_lshlrev_b32 v36, 16, v70
  v_and_b32 v37, 0xffff0000, v70
  v_add_f32 v32, v32, v36
  v_add_f32 v33, v33, v37
  v_lshlrev_b32 v36, 16, v71
  v_and_b32 v37, 0xffff0000, v71
  v_add_f32 v34, v34, v36
  v_add_f32 v35, v35, v37
  v_lshlrev_b32 v36, 16, v72
  v_and_b32 v37, 0xffff0000, v72
  v_add_f32 v28, v28, v36
  v_add_f32 v29, v29, v37
  v_lshlrev_b32 v36, 16, v73
  v_and_b32 v37, 0xffff0000, v73
  v_add_f32 v30, v30, v36
  v_add_f32 v31, v31, v37
  v_lshlrev_b32 v36, 16, v74
  v_and_b32 v37, 0xffff0000, v74
  v_add_f32 v32, v32, v36
  v_add_f32 v33, v33, v37
  v_lshlrev_b32 v36, 16, v75
  v_and_b32 v37, 0xffff0000, v75
  v_add_f32 v34, v34, v36
  v_add_f32 v35, v35, v37
  v_lshlrev_b32 v36, 16, v76
  v_and_b32 v37, 0xffff0000, v76
  v_add_f32 v28, v28, v36
  v_add_f32 v29, v29, v37
  v_lshlrev_b32 v36, 16, v77
  v_and_b32 v37, 0xffff0000, v77
  v_add_f32 v30, v30, v36
  v_add_f32 v31, v31, v37
  v_lshlrev_b32 v36, 16, v78
  v_and_b32 v37, 0xffff0000, v78
  v_add_f32 v32, v32, v36
  v_add_f32 v33, v33, v37
  v_lshlrev_b32 v36, 16, v79
  v_and_b32 v37, 0xffff0000, v79
  v_add_f32 v34, v34, v36
  v_add_f32 v35, v35, v37
  v_lshlrev_b32 v36, 16, v80
  v_and_b32 v37, 0xffff0000, v80
  v_add_f32 v28, v28, v36
  v_add_f32 v29, v29, v37
  v_lshlrev_b32 v36, 16, v81
  v_and_b32 v37, 0xffff0000, v81
  v_add_f32 v30, v30, v36
  v_add_f32 v31, v31, v37
  v_lshlrev_b32 v36, 16, v82
  v_and_b32 v37, 0xffff0000, v82
  v_add_f32 v32, v32, v36
  v_add_f32 v33, v33, v37
  v_lshlrev_b32 v36, 16, v83
  v_and_b32 v37, 0xffff0000, v83
  v_add_f32 v34, v34, v36
  v_add_f32 v35, v35, v37
  v_lshlrev_b32 v36, 16, v84
  v_and_b32 v37, 0xffff0000, v84
  v_add_f32 v28, v28, v36
  v_add_f32 v29, v29, v37
  v_lshlrev_b32 v36, 16, v85
  v_and_b32 v37, 0xffff0000, v85
  v_add_f32 v30, v30, v36
  v_add_f32 v31, v31, v37
  v_lshlrev_b32 v36, 16, v86
  v_and_b32 v37, 0xffff0000, v86
  v_add_f32 v32, v32, v36
  v_add_f32 v33, v33, v37
  v_lshlrev_b32 v36, 16, v87
  v_and_b32 v37, 0xffff0000, v87
  v_add_f32 v34, v34, v36
  v_add_f32 v35, v35, v37
  v_lshlrev_b32 v36, 16, v88
  v_and_b32 v37, 0xffff0000, v88
  v_add_f32 v28, v28, v36
  v_add_f32 v29, v29, v37
  v_lshlrev_b32 v36, 16, v89
  v_and_b32 v37, 0xffff0000, v89
  v_add_f32 v30, v30, v36
  v_add_f32 v31, v31, v37
  v_lshlrev_b32 v36, 16, v90
  v_and_b32 v37, 0xffff0000, v90
  v_add_f32 v32, v32, v36
  v_add_f32 v33, v33, v37
  v_lshlrev_b32 v36, 16, v91
  v_and_b32 v37, 0xffff0000, v91
  v_add_f32 v34, v34, v36
  v_add_f32 v35, v35, v37
  s_nop 1
  v_add_f32_dpp v28, v28, v28 quad_perm:[1,0,3,2] row_mask:0xf bank_mask:0xf
  v_add_f32_dpp v29, v29, v29 quad_perm:[1,0,3,2] row_mask:0xf bank_mask:0xf
  v_add_f32_dpp v30, v30, v30 quad_perm:[1,0,3,2] row_mask:0xf bank_mask:0xf
  v_add_f32_dpp v31, v31, v31 quad_perm:[1,0,3,2] row_mask:0xf bank_mask:0xf
  v_add_f32_dpp v32, v32, v32 quad_perm:[1,0,3,2] row_mask:0xf bank_mask:0xf
  v_add_f32_dpp v33, v33, v33 quad_perm:[1,0,3,2] row_mask:0xf bank_mask:0xf
  v_add_f32_dpp v34, v34, v34 quad_perm:[1,0,3,2] row_mask:0xf bank_mask:0xf
  v_add_f32_dpp v35, v35, v35 quad_perm:[1,0,3,2] row_mask:0xf bank_mask:0xf
  v_mov_b32 v36, v28
  v_mov_b32 v37, v29
  v_mov_b32 v38, v30
  v_mov_b32 v39, v31
  v_mov_b32 v40, v32
  v_mov_b32 v41, v33
  v_mov_b32 v42, v34
  v_mov_b32 v43, v35
  v_permlane16_swap_b32 v28, v36
  v_permlane16_swap_b32 v29, v37
  v_permlane16_swap_b32 v30, v38
  v_permlane16_swap_b32 v31, v39
  v_permlane16_swap_b32 v32, v40
  v_permlane16_swap_b32 v33, v41
  v_permlane16_swap_b32 v34, v42
  v_permlane16_swap_b32 v35, v43
  v_add_f32 v28, v28, v36
  v_add_f32 v29, v29, v37
  v_add_f32 v30, v30, v38
  v_add_f32 v31, v31, v39
  v_add_f32 v32, v32, v40
  v_add_f32 v33, v33, v41
  v_add_f32 v34, v34, v42
  v_add_f32 v35, v35, v43
  v_mov_b32 v36, v28
  v_mov_b32 v37, v29
  v_mov_b32 v38, v30
  v_mov_b32 v39, v31
  v_mov_b32 v40, v32
  v_mov_b32 v41, v33
  v_mov_b32 v42, v34
  v_mov_b32 v43, v35
  v_permlane32_swap_b32 v28, v36
  v_permlane32_swap_b32 v29, v37
  v_permlane32_swap_b32 v30, v38
  v_permlane32_swap_b32 v31, v39
  v_permlane32_swap_b32 v32, v40
  v_permlane32_swap_b32 v33, v41
  v_permlane32_swap_b32 v34, v42
  v_permlane32_swap_b32 v35, v43
  v_add_f32 v28, v28, v36
  v_add_f32 v29, v29, v37
  v_add_f32 v30, v30, v38
  v_add_f32 v31, v31, v39
  v_add_f32 v32, v32, v40
  v_add_f32 v33, v33, v41
  v_add_f32 v34, v34, v42
  v_add_f32 v35, v35, v43
  s_mul_i32 s61, s74, 14336
  s_lshl_b32 s62, s73, 8
  s_add_u32 s61, s61, s62
  s_add_u32 s61, s61, 13631488
  s_mov_b32 vcc_lo, 0xaaaaaaaa
  s_mov_b32 vcc_hi, 0xaaaaaaaa
  v_lshlrev_b32 v3, 4, v0
  v_cndmask_b32 v28, v28, v32, vcc
  v_cndmask_b32 v29, v29, v33, vcc
  v_cndmask_b32 v30, v30, v34, vcc
  v_cndmask_b32 v31, v31, v35, vcc
  s_mov_b64 exec, 0xffff
  buffer_store_dwordx4 v[28:31], v3, s[44:47], s61 offen sc1
  s_mov_b64 exec, -1
  s_barrier
  s_mov_b32 exec_hi, 0xffffff
  buffer_load_dword v59, v58, s[16:19], s68 offen
  s_mov_b32 exec_hi, -1
  s_add_u32 s68, s68, 229376
  s_barrier
  s_barrier
  s_barrier
  s_barrier
  s_waitcnt vmcnt(1)
  s_mov_b32 exec_hi, 0xffffff
  buffer_load_dword v59, v58, s[16:19], s68 offen
  s_mov_b32 exec_hi, -1
  s_add_u32 s68, s68, 229376
  s_lshl_b32 s72, s72, 7
  s_add_u32 s72, s72, 14778368
  s_barrier
  s_mov_b64 exec, 0xff
  v_lshlrev_b32 v57, 4, v0
  v_mov_b32 v32, s22
  v_mov_b32 v33, s23
  v_mov_b32 v34, s22
  v_mov_b32 v35, s23
  buffer_store_dwordx4 v[32:35], v57, s[44:47], s72 offen sc1
  s_mov_b64 exec, -1
  s_cmp_ge_u32 s58, 14
  s_cbranch_scc1 l_nog
  s_sleep 6
  s_add_u32 m0, s69, 98304
  s_add_u32 s79, s70, 57344
  buffer_load_dwordx4 v12, s[36:39], s70 offen offset:0 lds
  buffer_load_dwordx4 v13, s[36:39], s70 offen offset:1024 lds
  buffer_load_dwordx4 v14, s[36:39], s70 offen offset:2048 lds
  buffer_load_dwordx4 v15, s[36:39], s70 offen offset:3072 lds
  s_add_u32 m0, m0, 16384
  s_nop 0
  buffer_load_dwordx4 v12, s[40:43], s70 offen offset:0 lds
  buffer_load_dwordx4 v13, s[40:43], s70 offen offset:1024 lds
  buffer_load_dwordx4 v14, s[40:43], s70 offen offset:2048 lds
  buffer_load_dwordx4 v15, s[40:43], s70 offen offset:3072 lds
  s_add_u32 m0, s69, 102400
  s_add_u32 s79, s70, 57344
  buffer_load_dwordx4 v12, s[36:39], s79 offen offset:0 lds
  buffer_load_dwordx4 v13, s[36:39], s79 offen offset:1024 lds
  buffer_load_dwordx4 v14, s[36:39], s79 offen offset:2048 lds
  buffer_load_dwordx4 v15, s[36:39], s79 offen offset:3072 lds
  s_add_u32 m0, m0, 16384
  s_nop 0
  buffer_load_dwordx4 v12, s[40:43], s79 offen offset:0 lds
  buffer_load_dwordx4 v13, s[40:43], s79 offen offset:1024 lds
  buffer_load_dwordx4 v14, s[40:43], s79 offen offset:2048 lds
  buffer_load_dwordx4 v15, s[40:43], s79 offen offset:3072 lds
  s_add_u32 s70, s70, 229376
  s_barrier
  s_add_u32 m0, s69, 131072
  s_add_u32 s79, s70, 57344
  buffer_load_dwordx4 v12, s[36:39], s70 offen offset:0 lds
  buffer_load_dwordx4 v13, s[36:39], s70 offen offset:1024 lds
  buffer_load_dwordx4 v14, s[36:39], s70 offen offset:2048 lds
  buffer_load_dwordx4 v15, s[36:39], s70 offen offset:3072 lds
  s_add_u32 m0, m0, 16384
  s_nop 0
  buffer_load_dwordx4 v12, s[40:43], s70 offen offset:0 lds
  buffer_load_dwordx4 v13, s[40:43], s70 offen offset:1024 lds
  buffer_load_dwordx4 v14, s[40:43], s70 offen offset:2048 lds
  buffer_load_dwordx4 v15, s[40:43], s70 offen offset:3072 lds
  s_add_u32 m0, s69, 135168
  s_add_u32 s79, s70, 57344
  buffer_load_dwordx4 v12, s[36:39], s79 offen offset:0 lds
  buffer_load_dwordx4 v13, s[36:39], s79 offen offset:1024 lds
  buffer_load_dwordx4 v14, s[36:39], s79 offen offset:2048 lds
  buffer_load_dwordx4 v15, s[36:39], s79 offen offset:3072 lds
  s_add_u32 m0, m0, 16384
  s_nop 0
  buffer_load_dwordx4 v12, s[40:43], s79 offen offset:0 lds
  buffer_load_dwordx4 v13, s[40:43], s79 offen offset:1024 lds
  buffer_load_dwordx4 v14, s[40:43], s79 offen offset:2048 lds
  buffer_load_dwordx4 v15, s[40:43], s79 offen offset:3072 lds
  s_add_u32 s70, s70, 229376
  s_mov_b32 exec_hi, 0xffffff
  buffer_load_dword v59, v58, s[16:19], s68 offen
  s_mov_b32 exec_hi, -1
  s_add_u32 s68, s68, 229376
  s_branch l_join
l_nog:
  s_barrier
l_join:
  s_mov_b32 s48, s28
  s_mov_b32 s49, s29
  s_mov_b32 s50, 1835008
  s_mov_b32 s51, 0x20000
  v_lshrrev_b32 v3, 1, v1
  v_xor_b32 v4, v3, v2
  v_lshlrev_b32 v4, 4, v4
  s_lshl_b32 s62, s65, 4
  v_add_u32 v5, s62, v1
  v_mul_u32_u24 v52, 128, v5
  v_xor_b32 v53, 64, v4
  v_add_u32 v53, v53, v52
  v_add_u32 v53, 0, v53
  v_add_u32 v52, v52, v4
  v_and_b32 v3, 1, v3
  v_lshlrev_b32 v3, 2, v3
  v_xor_b32 v3, v3, v2
  v_lshlrev_b32 v3, 4, v3
  v_lshl_add_u32 v54, v5, 10, v3
  v_add_u32 v55, 7168, v54
  s_lshl_b32 s75, s65, 11
  s_lshl_b32 s77, s56, 7
  s_lshl_b32 s69, s65, 12
  s_mul_i32 s76, s55, 229376
  s_add_u32 s76, s76, 4194304
  s_cmp_ge_u32 s58, 14
  s_cbranch_scc1 l3_idle
  s_barrier
  s_add_u32 m0, s69, 0
  s_nop 0
  buffer_load_dwordx4 v48, s[44:47], s71 offen offset:0 sc1 lds
  buffer_load_dwordx4 v49, s[44:47], s71 offen offset:1024 sc1 lds
  buffer_load_dwordx4 v50, s[44:47], s71 offen offset:2048 sc1 lds
  buffer_load_dwordx4 v51, s[44:47], s71 offen offset:3072 sc1 lds
  s_add_u32 s71, s71, 8192
  s_add_u32 m0, s69, 16384
  s_nop 0
  buffer_load_dwordx4 v48, s[44:47], s71 offen offset:0 sc1 lds
  buffer_load_dwordx4 v49, s[44:47], s71 offen offset:1024 sc1 lds
  buffer_load_dwordx4 v50, s[44:47], s71 offen offset:2048 sc1 lds
  buffer_load_dwordx4 v51, s[44:47], s71 offen offset:3072 sc1 lds
  s_add_u32 s71, s71, 8192
  v_and_b32 v3, 31, v0
  v_lshlrev_b32 v4, 3, v3
  v_lshrrev_b32 v5, 5, v0
  v_lshl_add_u32 v4, v5, 16, v4
  s_lshl_b32 s61, s57, 10
  s_lshl_b32 s62, s65, 8
  s_add_u32 s61, s61, s62
  s_add_u32 s61, s61, 12582912
  buffer_load_dwordx2 v[20:21], v4, s[44:47], s61 offen sc1
  s_add_u32 s61, s61, 16384
  buffer_load_dwordx2 v[22:23], v4, s[44:47], s61 offen sc1
  s_add_u32 s61, s61, 16384
  buffer_load_dwordx2 v[24:25], v4, s[44:47], s61 offen sc1
  s_add_u32 s61, s61, 16384
  buffer_load_dwordx2 v[26:27], v4, s[44:47], s61 offen sc1
  s_add_u32 m0, s69, 32768
  s_nop 0
  buffer_load_dwordx4 v48, s[44:47], s71 offen offset:0 sc1 lds
  buffer_load_dwordx4 v49, s[44:47], s71 offen offset:1024 sc1 lds
  buffer_load_dwordx4 v50, s[44:47], s71 offen offset:2048 sc1 lds
  buffer_load_dwordx4 v51, s[44:47], s71 offen offset:3072 sc1 lds
  s_add_u32 s71, s71, 8192
  s_waitcnt vmcnt(12)
  s_barrier
  s_waitcnt vmcnt(8)
  s_barrier
  s_add_u32 m0, s69, 65536
  s_add_u32 s79, s70, 57344
  buffer_load_dwordx4 v44, s[36:39], s70 offen offset:0 lds
  buffer_load_dwordx4 v45, s[36:39], s70 offen offset:1024 lds
  buffer_load_dwordx4 v46, s[36:39], s70 offen offset:2048 lds
  buffer_load_dwordx4 v47, s[36:39], s70 offen offset:3072 lds
  s_add_u32 m0, m0, 16384
  s_nop 0
  buffer_load_dwordx4 v44, s[40:43], s70 offen offset:0 lds
  buffer_load_dwordx4 v45, s[40:43], s70 offen offset:1024 lds
  buffer_load_dwordx4 v46, s[40:43], s70 offen offset:2048 lds
  buffer_load_dwordx4 v47, s[40:43], s70 offen offset:3072 lds
  s_add_u32 s70, s70, 229376
  s_add_u32 m0, s69, 0
  s_nop 0
  buffer_load_dwordx4 v48, s[44:47], s71 offen offset:0 sc1 lds
  buffer_load_dwordx4 v49, s[44:47], s71 offen offset:1024 sc1 lds
  buffer_load_dwordx4 v50, s[44:47], s71 offen offset:2048 sc1 lds
  buffer_load_dwordx4 v51, s[44:47], s71 offen offset:3072 sc1 lds
  s_add_u32 s71, s71, 8192
  s_waitcnt vmcnt(16)
  s_mov_b32 s72, 0x3b000000
  s_mov_b32 s73, 0x3727c5ac
  s_mov_b32 s74, 0xbfb8aa3b
  v_add_f32 v20, v20, v22
  v_add_f32 v21, v21, v23
  v_add_f32 v20, v20, v24
  v_add_f32 v21, v21, v25
  v_add_f32 v20, v20, v26
  v_add_f32 v21, v21, v27
  v_mov_b32 v22, v20
  v_mov_b32 v23, v21
  s_nop 1
  v_permlane32_swap_b32 v20, v22
  v_permlane32_swap_b32 v21, v23
  v_add_f32 v20, v20, v22
  v_add_f32 v21, v21, v23
  v_mul_f32 v22, s72, v20
  v_mul_f32 v27, s72, v21
  v_fma_f32 v27, -v22, v22, v27
  v_max_f32 v27, 0, v27
  v_cvt_pk_bf16_f32 v22, v22, v22
  v_lshlrev_b32 v22, 16, v22
  v_cvt_pk_bf16_f32 v27, v27, v27
  v_lshlrev_b32 v27, 16, v27
  v_add_f32 v27, s73, v27
  v_cvt_pk_bf16_f32 v27, v27, v27
  v_lshlrev_b32 v27, 16, v27
  v_sqrt_f32 v27, v27
  s_nop 0
  v_cvt_pk_bf16_f32 v27, v27, v27
  v_lshlrev_b32 v27, 16, v27
  v_rcp_f32 v23, v27
  s_nop 0
  v_xor_b32 v22, 0x80000000, v22
  v_lshrrev_b32 v29, 16, v22
  v_or_b32 v28, v22, v29
  v_mul_f32 v30, s74, v23
  v_mul_f32 v31, v27, v27
  s_lshl_b32 s61, s65, 9
  s_add_u32 s61, s61, 49152
  v_lshl_add_u32 v3, v3, 4, s61
  s_mov_b32 exec_hi, 0
  ds_write_b128 v3, v[28:31]
  s_mov_b32 exec_hi, -1
  s_waitcnt lgkmcnt(0)
  s_waitcnt vmcnt(12)
  s_barrier
  s_lshr_b32 s61, s65, 1
  s_mul_i32 s61, s61, 28
  s_and_b32 s62, s65, 1
  s_add_u32 s61, s61, s62
  s_lshl_b32 s62, s58, 1
  s_add_u32 s73, s61, s62
  s_lshl_b32 s74, s73, 10
  s_add_u32 s74, s74, 14778368
  v_and_b32 v57, 7, v0
  v_lshlrev_b32 v57, 7, v57
  buffer_load_dwordx2 v[16:17], v57, s[44:47], s74 offen sc1
  s_add_u32 m0, s69, 98304
  s_add_u32 s79, s70, 57344
  buffer_load_dwordx4 v44, s[36:39], s70 offen offset:0 lds
  buffer_load_dwordx4 v45, s[36:39], s70 offen offset:1024 lds
  buffer_load_dwordx4 v46, s[36:39], s70 offen offset:2048 lds
  buffer_load_dwordx4 v47, s[36:39], s70 offen offset:3072 lds
  s_add_u32 m0, m0, 16384
  s_nop 0
  buffer_load_dwordx4 v44, s[40:43], s70 offen offset:0 lds
  buffer_load_dwordx4 v45, s[40:43], s70 offen offset:1024 lds
  buffer_load_dwordx4 v46, s[40:43], s70 offen offset:2048 lds
  buffer_load_dwordx4 v47, s[40:43], s70 offen offset:3072 lds
  s_add_u32 s70, s70, 229376
  s_add_u32 m0, s69, 16384
  s_nop 0
  buffer_load_dwordx4 v48, s[44:47], s71 offen offset:0 sc1 lds
  buffer_load_dwordx4 v49, s[44:47], s71 offen offset:1024 sc1 lds
  buffer_load_dwordx4 v50, s[44:47], s71 offen offset:2048 sc1 lds
  buffer_load_dwordx4 v51, s[44:47], s71 offen offset:3072 sc1 lds
  s_add_u32 s71, s71, 8192
  s_waitcnt vmcnt(12)
  v_cmp_ne_u64 vcc, s[22:23], v[16:17]
  s_lshl_b32 s61, s73, 8
  s_add_u32 s61, s61, 13631488
  s_cmp_eq_u64 vcc, 0
  s_cbranch_scc1 fc_ok
  v_min_u32 v57, 7, v0
  v_lshlrev_b32 v57, 7, v57
  s_mov_b32 s64, 32768
poll_16:
  buffer_load_dwordx2 v[16:17], v57, s[44:47], s74 offen sc1
  s_waitcnt vmcnt(0)
  v_cmp_ne_u64 vcc, s[22:23], v[16:17]
  s_nop 1
  s_cmp_eq_u64 vcc, 0
  s_cbranch_scc1 polld_17
  s_sleep 1
  s_sub_u32 s64, s64, 1
  s_cbranch_scc0 poll_16
polld_17:
fc_ok:
  buffer_load_dword v60, v6, s[44:47], s61 offen sc1
  s_add_u32 s61, s61, 14336
  buffer_load_dword v61, v6, s[44:47], s61 offen sc1
  s_add_u32 s61, s61, 14336
  buffer_load_dword v62, v6, s[44:47], s61 offen sc1
  s_add_u32 s61, s61, 14336
  buffer_load_dword v63, v6, s[44:47], s61 offen sc1
  s_add_u32 s61, s61, 14336
  buffer_load_dword v64, v6, s[44:47], s61 offen sc1
  s_add_u32 s61, s61, 14336
  buffer_load_dword v65, v6, s[44:47], s61 offen sc1
  s_add_u32 s61, s61, 14336
  buffer_load_dword v66, v6, s[44:47], s61 offen sc1
  s_add_u32 s61, s61, 14336
  buffer_load_dword v67, v6, s[44:47], s61 offen sc1
  s_waitcnt vmcnt(21)
  s_barrier
  s_add_u32 m0, s69, 131072
  s_add_u32 s79, s70, 57344
  buffer_load_dwordx4 v44, s[36:39], s70 offen offset:0 lds
  buffer_load_dwordx4 v45, s[36:39], s70 offen offset:1024 lds
  buffer_load_dwordx4 v46, s[36:39], s70 offen offset:2048 lds
  buffer_load_dwordx4 v47, s[36:39], s70 offen offset:3072 lds
  s_add_u32 m0, m0, 16384
  s_nop 0
  buffer_load_dwordx4 v44, s[40:43], s70 offen offset:0 lds
  buffer_load_dwordx4 v45, s[40:43], s70 offen offset:1024 lds
  buffer_load_dwordx4 v46, s[40:43], s70 offen offset:2048 lds
  buffer_load_dwordx4 v47, s[40:43], s70 offen offset:3072 lds
  s_add_u32 s70, s70, 229376
  s_add_u32 m0, s69, 32768
  s_nop 0
  buffer_load_dwordx4 v48, s[44:47], s71 offen offset:0 sc1 lds
  buffer_load_dwordx4 v49, s[44:47], s71 offen offset:1024 sc1 lds
  buffer_load_dwordx4 v50, s[44:47], s71 offen offset:2048 sc1 lds
  buffer_load_dwordx4 v51, s[44:47], s71 offen offset:3072 sc1 lds
  s_add_u32 s71, s71, 8192
  s_waitcnt vmcnt(12)
  v_add_f32 v60, v60, v64
  v_add_f32 v61, v61, v65
  v_add_f32 v62, v62, v66
  v_add_f32 v63, v63, v67
  v_add_f32 v60, v60, v62
  v_add_f32 v61, v61, v63
  v_add_f32 v60, v60, v61
  s_mov_b32 s61, 0xffff0000
  v_and_b32 v61, s61, v60
  v_sub_f32 v61, v60, v61
  v_lshrrev_b32 v60, 16, v60
  v_and_b32 v62, s61, v61
  v_sub_f32 v61, v61, v62
  v_or_b32 v60, v60, v62
  v_lshrrev_b32 v61, 16, v61
  s_lshl_b32 s61, s65, 9
  s_add_u32 s61, s61, 51200
  v_lshl_add_u32 v4, v0, 3, s61
  ds_write_b64 v4, v[60:61]
  s_waitcnt lgkmcnt(0)
  s_waitcnt vmcnt(20)
  s_barrier
  s_add_u32 m0, s69, 65536
  s_add_u32 s79, s70, 57344
  buffer_load_dwordx4 v44, s[36:39], s70 offen offset:0 lds
  buffer_load_dwordx4 v45, s[36:39], s70 offen offset:1024 lds
  buffer_load_dwordx4 v46, s[36:39], s70 offen offset:2048 lds
  buffer_load_dwordx4 v47, s[36:39], s70 offen offset:3072 lds
  s_add_u32 m0, m0, 16384
  s_nop 0
  buffer_load_dwordx4 v44, s[40:43], s70 offen offset:0 lds
  buffer_load_dwordx4 v45, s[40:43], s70 offen offset:1024 lds
  buffer_load_dwordx4 v46, s[40:43], s70 offen offset:2048 lds
  buffer_load_dwordx4 v47, s[40:43], s70 offen offset:3072 lds
  s_add_u32 s70, s70, 229376
  s_add_u32 m0, s69, 0
  s_nop 0
  buffer_load_dwordx4 v48, s[44:47], s71 offen offset:0 sc1 lds
  buffer_load_dwordx4 v49, s[44:47], s71 offen offset:1024 sc1 lds
  buffer_load_dwordx4 v50, s[44:47], s71 offen offset:2048 sc1 lds
  buffer_load_dwordx4 v51, s[44:47], s71 offen offset:3072 sc1 lds
  s_add_u32 s71, s71, 8192
  s_lshl_b32 s61, s57, 5
  s_add_u32 s61, s61, s58
  s_add_u32 s61, s61, 117248
  s_lshl_b32 s61, s61, 7
  s_mov_b64 exec, 0xff
  v_lshlrev_b32 v3, 4, v0
  v_mov_b32 v36, 0
  v_mov_b32 v37, 0
  v_mov_b32 v38, 0
  v_mov_b32 v39, 0
  buffer_store_dwordx4 v[36:39], v3, s[44:47], s61 offen
  s_mov_b64 exec, -1
  s_waitcnt vmcnt(13)
  s_barrier
  s_add_u32 m0, s69, 98304
  s_add_u32 s79, s70, 57344
  buffer_load_dwordx4 v44, s[36:39], s70 offen offset:0 lds
  buffer_load_dwordx4 v45, s[36:39], s70 offen offset:1024 lds
  buffer_load_dwordx4 v46, s[36:39], s70 offen offset:2048 lds
  buffer_load_dwordx4 v47, s[36:39], s70 offen offset:3072 lds
  s_add_u32 m0, m0, 16384
  s_nop 0
  buffer_load_dwordx4 v44, s[40:43], s70 offen offset:0 lds
  buffer_load_dwordx4 v45, s[40:43], s70 offen offset:1024 lds
  buffer_load_dwordx4 v46, s[40:43], s70 offen offset:2048 lds
  buffer_load_dwordx4 v47, s[40:43], s70 offen offset:3072 lds
  s_add_u32 s70, s70, 229376
  s_add_u32 m0, s69, 16384
  s_nop 0
  buffer_load_dwordx4 v48, s[44:47], s71 offen offset:0 sc1 lds
  buffer_load_dwordx4 v49, s[44:47], s71 offen offset:1024 sc1 lds
  buffer_load_dwordx4 v50, s[44:47], s71 offen offset:2048 sc1 lds
  buffer_load_dwordx4 v51, s[44:47], s71 offen offset:3072 sc1 lds
  s_add_u32 s71, s71, 8192
  s_waitcnt vmcnt(13)
  s_barrier
  s_add_u32 m0, s75, 131072
  s_add_u32 s79, s77, 16384
  buffer_load_dwordx4 v54, s[48:51], s77 offen lds
  buffer_load_dwordx4 v55, s[48:51], s77 offen offset:1024 lds
  s_add_u32 s77, s77, 65536
  s_add_u32 m0, s75, 139264
  s_add_u32 s79, s77, 16384
  buffer_load_dwordx4 v54, s[48:51], s77 offen lds
  buffer_load_dwordx4 v55, s[48:51], s77 offen offset:1024 lds
  s_add_u32 s77, s77, 65536
  s_add_u32 m0, s75, 147456
  s_add_u32 s79, s77, 16384
  buffer_load_dwordx4 v54, s[48:51], s77 offen lds
  buffer_load_dwordx4 v55, s[48:51], s77 offen offset:1024 lds
  s_add_u32 s77, s77, 65536
  s_add_u32 m0, s75, 155648
  s_add_u32 s79, s77, 16384
  buffer_load_dwordx4 v54, s[48:51], s77 offen lds
  buffer_load_dwordx4 v55, s[48:51], s77 offen offset:1024 lds
  s_add_u32 s77, s77, 65536
  s_waitcnt vmcnt(8)
  s_barrier
  s_add_u32 m0, s75, 65536
  s_add_u32 s79, s77, 16384
  buffer_load_dwordx4 v54, s[48:51], s77 offen lds
  buffer_load_dwordx4 v55, s[48:51], s77 offen offset:1024 lds
  s_add_u32 s77, s77, 65536
  s_add_u32 m0, s75, 73728
  s_add_u32 s79, s77, 16384
  buffer_load_dwordx4 v54, s[48:51], s77 offen lds
  buffer_load_dwordx4 v55, s[48:51], s77 offen offset:1024 lds
  s_add_u32 s77, s77, 65536
  s_add_u32 m0, s75, 81920
  s_add_u32 s79, s77, 16384
  buffer_load_dwordx4 v54, s[48:51], s77 offen lds
  buffer_load_dwordx4 v55, s[48:51], s77 offen offset:1024 lds
  s_add_u32 s77, s77, 65536
  s_add_u32 m0, s75, 90112
  s_add_u32 s79, s77, 16384
  buffer_load_dwordx4 v54, s[48:51], s77 offen lds
  buffer_load_dwordx4 v55, s[48:51], s77 offen offset:1024 lds
  s_add_u32 s77, s77, 65536
  s_barrier
  s_add_u32 m0, s75, 98304
  s_add_u32 s79, s77, 16384
  buffer_load_dwordx4 v54, s[48:51], s77 offen lds
  buffer_load_dwordx4 v55, s[48:51], s77 offen offset:1024 lds
  s_add_u32 s77, s77, 65536
  s_add_u32 m0, s75, 106496
  s_add_u32 s79, s77, 16384
  buffer_load_dwordx4 v54, s[48:51], s77 offen lds
  buffer_load_dwordx4 v55, s[48:51], s77 offen offset:1024 lds
  s_add_u32 s77, s77, 65536
  s_add_u32 m0, s75, 114688
  s_add_u32 s79, s77, 16384
  buffer_load_dwordx4 v54, s[48:51], s77 offen lds
  buffer_load_dwordx4 v55, s[48:51], s77 offen offset:1024 lds
  s_add_u32 s77, s77, 65536
  s_add_u32 m0, s75, 122880
  s_add_u32 s79, s77, 16384
  buffer_load_dwordx4 v54, s[48:51], s77 offen lds
  buffer_load_dwordx4 v55, s[48:51], s77 offen offset:1024 lds
  s_add_u32 s77, s77, 65536
  s_lshl_b32 s61, s57, 5
  s_add_u32 s61, s61, s58
  s_lshl_b32 s61, s61, 7
  s_add_u32 s61, s61, 15007744
  s_xor_b32 s61, s61, 0
  s_cmp_lg_u32 s65, 0
  s_barrier
  s_cbranch_scc1 nf3
  s_mov_b64 exec, 0xff
  v_lshlrev_b32 v3, 4, v0
  v_mov_b32 v32, s22
  v_mov_b32 v33, s23
  v_mov_b32 v34, s22
  v_mov_b32 v35, s23
  buffer_store_dwordx4 v[32:35], v3, s[44:47], s61 offen
  buffer_store_dwordx4 v[32:35], v3, s[44:47], s61 offen offset:2048 sc1
  s_mov_b64 exec, -1
  s_waitcnt vmcnt(2)
  s_branch nf3b
nf3:
  s_waitcnt vmcnt(0)
nf3b:
  s_barrier
  s_branch l4_start
l3_idle:
  s_waitcnt vmcnt(0)
  s_add_u32 m0, s75, 131072
  s_add_u32 s79, s77, 16384
  buffer_load_dwordx4 v54, s[48:51], s77 offen lds
  buffer_load_dwordx4 v55, s[48:51], s77 offen offset:1024 lds
  s_add_u32 s77, s77, 65536
  s_add_u32 m0, s75, 139264
  s_add_u32 s79, s77, 16384
  buffer_load_dwordx4 v54, s[48:51], s77 offen lds
  buffer_load_dwordx4 v55, s[48:51], s77 offen offset:1024 lds
  s_add_u32 s77, s77, 65536
  s_add_u32 m0, s75, 147456
  s_add_u32 s79, s77, 16384
  buffer_load_dwordx4 v54, s[48:51], s77 offen lds
  buffer_load_dwordx4 v55, s[48:51], s77 offen offset:1024 lds
  s_add_u32 s77, s77, 65536
  s_add_u32 m0, s75, 155648
  s_add_u32 s79, s77, 16384
  buffer_load_dwordx4 v54, s[48:51], s77 offen lds
  buffer_load_dwordx4 v55, s[48:51], s77 offen offset:1024 lds
  s_add_u32 s77, s77, 65536
  s_add_u32 m0, s75, 65536
  s_add_u32 s79, s77, 16384
  buffer_load_dwordx4 v54, s[48:51], s77 offen lds
  buffer_load_dwordx4 v55, s[48:51], s77 offen offset:1024 lds
  s_add_u32 s77, s77, 65536
  s_add_u32 m0, s75, 73728
  s_add_u32 s79, s77, 16384
  buffer_load_dwordx4 v54, s[48:51], s77 offen lds
  buffer_load_dwordx4 v55, s[48:51], s77 offen offset:1024 lds
  s_add_u32 s77, s77, 65536
  s_add_u32 m0, s75, 81920
  s_add_u32 s79, s77, 16384
  buffer_load_dwordx4 v54, s[48:51], s77 offen lds
  buffer_load_dwordx4 v55, s[48:51], s77 offen offset:1024 lds
  s_add_u32 s77, s77, 65536
  s_add_u32 m0, s75, 90112
  s_add_u32 s79, s77, 16384
  buffer_load_dwordx4 v54, s[48:51], s77 offen lds
  buffer_load_dwordx4 v55, s[48:51], s77 offen offset:1024 lds
  s_add_u32 s77, s77, 65536
  s_add_u32 m0, s75, 98304
  s_add_u32 s79, s77, 16384
  buffer_load_dwordx4 v54, s[48:51], s77 offen lds
  buffer_load_dwordx4 v55, s[48:51], s77 offen offset:1024 lds
  s_add_u32 s77, s77, 65536
  s_add_u32 m0, s75, 106496
  s_add_u32 s79, s77, 16384
  buffer_load_dwordx4 v54, s[48:51], s77 offen lds
  buffer_load_dwordx4 v55, s[48:51], s77 offen offset:1024 lds
  s_add_u32 s77, s77, 65536
  s_add_u32 m0, s75, 114688
  s_add_u32 s79, s77, 16384
  buffer_load_dwordx4 v54, s[48:51], s77 offen lds
  buffer_load_dwordx4 v55, s[48:51], s77 offen offset:1024 lds
  s_add_u32 s77, s77, 65536
  s_add_u32 m0, s75, 122880
  s_add_u32 s79, s77, 16384
  buffer_load_dwordx4 v54, s[48:51], s77 offen lds
  buffer_load_dwordx4 v55, s[48:51], s77 offen offset:1024 lds
  s_add_u32 s77, s77, 65536
  s_waitcnt vmcnt(0)
  s_barrier
l4_start:
  s_barrier
  s_add_u32 m0, s75, 131072
  s_add_u32 s79, s77, 16384
  buffer_load_dwordx4 v54, s[48:51], s77 offen lds
  buffer_load_dwordx4 v55, s[48:51], s77 offen offset:1024 lds
  s_add_u32 s77, s77, 65536
  s_add_u32 m0, s75, 139264
  s_add_u32 s79, s77, 16384
  buffer_load_dwordx4 v54, s[48:51], s77 offen lds
  buffer_load_dwordx4 v55, s[48:51], s77 offen offset:1024 lds
  s_add_u32 s77, s77, 65536
  s_add_u32 m0, s75, 147456
  s_add_u32 s79, s77, 16384
  buffer_load_dwordx4 v54, s[48:51], s77 offen lds
  buffer_load_dwordx4 v55, s[48:51], s77 offen offset:1024 lds
  s_add_u32 s77, s77, 65536
  s_add_u32 m0, s75, 155648
  s_add_u32 s79, s77, 16384
  buffer_load_dwordx4 v54, s[48:51], s77 offen lds
  buffer_load_dwordx4 v55, s[48:51], s77 offen offset:1024 lds
  s_add_u32 s77, s77, 65536
  s_add_u32 m0, s75, 65536
  s_add_u32 s79, s77, 16384
  buffer_load_dwordx4 v54, s[48:51], s77 offen lds
  buffer_load_dwordx4 v55, s[48:51], s77 offen offset:1024 lds
  s_add_u32 s77, s77, 65536
  s_add_u32 m0, s75, 73728
  s_add_u32 s79, s77, 16384
  buffer_load_dwordx4 v54, s[48:51], s77 offen lds
  buffer_load_dwordx4 v55, s[48:51], s77 offen offset:1024 lds
  s_add_u32 s77, s77, 65536
  s_add_u32 m0, s75, 81920
  s_add_u32 s79, s77, 16384
  buffer_load_dwordx4 v54, s[48:51], s77 offen lds
  buffer_load_dwordx4 v55, s[48:51], s77 offen offset:1024 lds
  s_add_u32 s77, s77, 65536
  s_add_u32 m0, s75, 90112
  s_add_u32 s79, s77, 16384
  buffer_load_dwordx4 v54, s[48:51], s77 offen lds
  buffer_load_dwordx4 v55, s[48:51], s77 offen offset:1024 lds
  s_add_u32 s77, s77, 65536
  s_add_u32 m0, s75, 98304
  s_add_u32 s79, s77, 16384
  buffer_load_dwordx4 v54, s[48:51], s77 offen lds
  buffer_load_dwordx4 v55, s[48:51], s77 offen offset:1024 lds
  s_add_u32 s77, s77, 65536
  s_add_u32 m0, s75, 106496
  s_add_u32 s79, s77, 16384
  buffer_load_dwordx4 v54, s[48:51], s77 offen lds
  buffer_load_dwordx4 v55, s[48:51], s77 offen offset:1024 lds
  s_add_u32 s77, s77, 65536
  s_add_u32 m0, s75, 114688
  s_add_u32 s79, s77, 16384
  buffer_load_dwordx4 v54, s[48:51], s77 offen lds
  buffer_load_dwordx4 v55, s[48:51], s77 offen offset:1024 lds
  s_add_u32 s77, s77, 65536
  s_add_u32 m0, s75, 122880
  s_add_u32 s79, s77, 16384
  buffer_load_dwordx4 v54, s[48:51], s77 offen lds
  buffer_load_dwordx4 v55, s[48:51], s77 offen offset:1024 lds
  s_add_u32 s77, s77, 65536
  s_waitcnt vmcnt(12)
  s_barrier
  s_barrier
  s_add_u32 m0, s75, 0
  s_add_u32 s79, s76, 2048
  buffer_load_dwordx4 v52, s[44:47], s76 offen sc1 lds
  buffer_load_dwordx4 v53, s[44:47], s76 offen offset:1024 sc1 lds
  s_add_u32 s76, s76, 8192
  s_add_u32 m0, s75, 8192
  s_add_u32 s79, s76, 2048
  buffer_load_dwordx4 v52, s[44:47], s76 offen sc1 lds
  buffer_load_dwordx4 v53, s[44:47], s76 offen offset:1024 sc1 lds
  s_add_u32 s76, s76, 8192
  s_add_u32 m0, s75, 16384
  s_add_u32 s79, s76, 2048
  buffer_load_dwordx4 v52, s[44:47], s76 offen sc1 lds
  buffer_load_dwordx4 v53, s[44:47], s76 offen offset:1024 sc1 lds
  s_add_u32 s76, s76, 8192
  s_add_u32 m0, s75, 24576
  s_add_u32 s79, s76, 2048
  buffer_load_dwordx4 v52, s[44:47], s76 offen sc1 lds
  buffer_load_dwordx4 v53, s[44:47], s76 offen offset:1024 sc1 lds
  s_add_u32 s76, s76, 8192
  s_add_u32 m0, s75, 32768
  s_add_u32 s79, s76, 2048
  buffer_load_dwordx4 v52, s[44:47], s76 offen sc1 lds
  buffer_load_dwordx4 v53, s[44:47], s76 offen offset:1024 sc1 lds
  s_add_u32 s76, s76, 8192
  s_add_u32 m0, s75, 40960
  s_add_u32 s79, s76, 2048
  buffer_load_dwordx4 v52, s[44:47], s76 offen sc1 lds
  buffer_load_dwordx4 v53, s[44:47], s76 offen offset:1024 sc1 lds
  s_add_u32 s76, s76, 8192
  s_add_u32 m0, s75, 49152
  s_add_u32 s79, s76, 2048
  buffer_load_dwordx4 v52, s[44:47], s76 offen sc1 lds
  buffer_load_dwordx4 v53, s[44:47], s76 offen offset:1024 sc1 lds
  s_add_u32 s76, s76, 8192
  s_add_u32 m0, s75, 57344
  s_add_u32 s79, s76, 2048
  buffer_load_dwordx4 v52, s[44:47], s76 offen sc1 lds
  buffer_load_dwordx4 v53, s[44:47], s76 offen offset:1024 sc1 lds
  s_add_u32 s76, s76, 8192
  s_waitcnt vmcnt(12)
  s_barrier
  s_add_u32 m0, s75, 65536
  s_add_u32 s79, s76, 2048
  buffer_load_dwordx4 v52, s[44:47], s76 offen sc1 lds
  buffer_load_dwordx4 v53, s[44:47], s76 offen offset:1024 sc1 lds
  s_add_u32 s76, s76, 8192
  s_add_u32 m0, s75, 73728
  s_add_u32 s79, s76, 2048
  buffer_load_dwordx4 v52, s[44:47], s76 offen sc1 lds
  buffer_load_dwordx4 v53, s[44:47], s76 offen offset:1024 sc1 lds
  s_add_u32 s76, s76, 8192
  s_add_u32 m0, s75, 131072
  s_add_u32 s79, s76, 2048
  buffer_load_dwordx4 v52, s[44:47], s76 offen sc1 lds
  buffer_load_dwordx4 v53, s[44:47], s76 offen offset:1024 sc1 lds
  s_add_u32 s76, s76, 8192
  s_add_u32 m0, s75, 139264
  s_add_u32 s79, s76, 2048
  buffer_load_dwordx4 v52, s[44:47], s76 offen sc1 lds
  buffer_load_dwordx4 v53, s[44:47], s76 offen offset:1024 sc1 lds
  s_add_u32 s76, s76, 8192
  s_waitcnt vmcnt(16)
  s_barrier
  s_add_u32 m0, s75, 147456
  s_add_u32 s79, s76, 2048
  buffer_load_dwordx4 v52, s[44:47], s76 offen sc1 lds
  buffer_load_dwordx4 v53, s[44:47], s76 offen offset:1024 sc1 lds
  s_add_u32 s76, s76, 8192
  s_add_u32 m0, s75, 155648
  s_add_u32 s79, s76, 2048
  buffer_load_dwordx4 v52, s[44:47], s76 offen sc1 lds
  buffer_load_dwordx4 v53, s[44:47], s76 offen offset:1024 sc1 lds
  s_add_u32 s76, s76, 8192
  s_add_u32 m0, s75, 0
  s_add_u32 s79, s76, 2048
  buffer_load_dwordx4 v52, s[44:47], s76 offen sc1 lds
  buffer_load_dwordx4 v53, s[44:47], s76 offen offset:1024 sc1 lds
  s_add_u32 s76, s76, 8192
  s_add_u32 m0, s75, 8192
  s_add_u32 s79, s76, 2048
  buffer_load_dwordx4 v52, s[44:47], s76 offen sc1 lds
  buffer_load_dwordx4 v53, s[44:47], s76 offen offset:1024 sc1 lds
  s_add_u32 s76, s76, 8192
  s_waitcnt vmcnt(20)
  s_barrier
  s_add_u32 m0, s75, 16384
  s_add_u32 s79, s76, 2048
  buffer_load_dwordx4 v52, s[44:47], s76 offen sc1 lds
  buffer_load_dwordx4 v53, s[44:47], s76 offen offset:1024 sc1 lds
  s_add_u32 s76, s76, 8192
  s_add_u32 m0, s75, 24576
  s_add_u32 s79, s76, 2048
  buffer_load_dwordx4 v52, s[44:47], s76 offen sc1 lds
  buffer_load_dwordx4 v53, s[44:47], s76 offen offset:1024 sc1 lds
  s_add_u32 s76, s76, 8192
  s_waitcnt vmcnt(20)
  s_barrier
  s_add_u32 m0, s75, 32768
  s_add_u32 s79, s76, 2048
  buffer_load_dwordx4 v52, s[44:47], s76 offen sc1 lds
  buffer_load_dwordx4 v53, s[44:47], s76 offen offset:1024 sc1 lds
  s_add_u32 s76, s76, 8192
  s_add_u32 m0, s75, 40960
  s_add_u32 s79, s76, 2048
  buffer_load_dwordx4 v52, s[44:47], s76 offen sc1 lds
  buffer_load_dwordx4 v53, s[44:47], s76 offen offset:1024 sc1 lds
  s_add_u32 s76, s76, 8192
  s_waitcnt vmcnt(20)
  s_barrier
  s_add_u32 m0, s75, 49152
  s_add_u32 s79, s76, 2048
  buffer_load_dwordx4 v52, s[44:47], s76 offen sc1 lds
  buffer_load_dwordx4 v53, s[44:47], s76 offen offset:1024 sc1 lds
  s_add_u32 s76, s76, 8192
  s_add_u32 m0, s75, 57344
  s_add_u32 s79, s76, 2048
  buffer_load_dwordx4 v52, s[44:47], s76 offen sc1 lds
  buffer_load_dwordx4 v53, s[44:47], s76 offen offset:1024 sc1 lds
  s_add_u32 s76, s76, 8192
  s_waitcnt vmcnt(20)
  s_barrier
  s_add_u32 m0, s75, 65536
  s_add_u32 s79, s76, 2048
  buffer_load_dwordx4 v52, s[44:47], s76 offen sc1 lds
  buffer_load_dwordx4 v53, s[44:47], s76 offen offset:1024 sc1 lds
  s_add_u32 s76, s76, 8192
  s_add_u32 m0, s75, 73728
  s_add_u32 s79, s76, 2048
  buffer_load_dwordx4 v52, s[44:47], s76 offen sc1 lds
  buffer_load_dwordx4 v53, s[44:47], s76 offen offset:1024 sc1 lds
  s_add_u32 s76, s76, 8192
  s_waitcnt vmcnt(20)
  s_barrier
  s_add_u32 m0, s75, 131072
  s_add_u32 s79, s77, 16384
  buffer_load_dwordx4 v54, s[48:51], s77 offen lds
  buffer_load_dwordx4 v55, s[48:51], s77 offen offset:1024 lds
  s_add_u32 s77, s77, 65536
  s_add_u32 m0, s75, 139264
  s_add_u32 s79, s77, 16384
  buffer_load_dwordx4 v54, s[48:51], s77 offen lds
  buffer_load_dwordx4 v55, s[48:51], s77 offen offset:1024 lds
  s_add_u32 s77, s77, 65536
  s_waitcnt vmcnt(20)
  s_barrier
  s_add_u32 m0, s75, 147456
  s_add_u32 s79, s77, 16384
  buffer_load_dwordx4 v54, s[48:51], s77 offen lds
  buffer_load_dwordx4 v55, s[48:51], s77 offen offset:1024 lds
  s_add_u32 s77, s77, 65536
  s_add_u32 m0, s75, 155648
  s_add_u32 s79, s77, 16384
  buffer_load_dwordx4 v54, s[48:51], s77 offen lds
  buffer_load_dwordx4 v55, s[48:51], s77 offen offset:1024 lds
  s_add_u32 s77, s77, 65536
  s_waitcnt vmcnt(20)
  s_barrier
  s_add_u32 m0, s75, 0
  s_add_u32 s79, s76, 2048
  buffer_load_dwordx4 v52, s[44:47], s76 offen sc1 lds
  buffer_load_dwordx4 v53, s[44:47], s76 offen offset:1024 sc1 lds
  s_add_u32 s76, s76, 8192
  s_add_u32 m0, s75, 8192
  s_add_u32 s79, s76, 2048
  buffer_load_dwordx4 v52, s[44:47], s76 offen sc1 lds
  buffer_load_dwordx4 v53, s[44:47], s76 offen offset:1024 sc1 lds
  s_add_u32 s76, s76, 8192
  s_waitcnt vmcnt(20)
  s_barrier
  s_add_u32 m0, s75, 16384
  s_add_u32 s79, s76, 2048
  buffer_load_dwordx4 v52, s[44:47], s76 offen sc1 lds
  buffer_load_dwordx4 v53, s[44:47], s76 offen offset:1024 sc1 lds
  s_add_u32 s76, s76, 8192
  s_add_u32 m0, s75, 24576
  s_add_u32 s79, s76, 2048
  buffer_load_dwordx4 v52, s[44:47], s76 offen sc1 lds
  buffer_load_dwordx4 v53, s[44:47], s76 offen offset:1024 sc1 lds
  s_add_u32 s76, s76, 8192
  s_waitcnt vmcnt(20)
  s_barrier
  s_waitcnt vmcnt(16)
  s_barrier
  s_waitcnt vmcnt(4)
  s_barrier
  s_waitcnt vmcnt(0)
  s_barrier
mega_kernel_end:
  s_endpgm
.section .rodata,"a"
.p2align 6
.amdhsa_kernel mega_kernel
  .amdhsa_next_free_vgpr 256
  .amdhsa_next_free_sgpr 102
  .amdhsa_accum_offset 256
  .amdhsa_group_segment_fixed_size 0
  .amdhsa_kernarg_size 80
  .amdhsa_user_sgpr_count 2
  .amdhsa_user_sgpr_kernarg_segment_ptr 1
  .amdhsa_system_sgpr_workgroup_id_x 1
.end_amdhsa_kernel
```
